```python
import torch

def _softmax(x, axis=-1):
    return torch.softmax(x, dim=axis)
def _gelu(x):
    return torch.nn.functional.gelu(x, approximate="tanh")
def _silu(x):
    return torch.nn.functional.silu(x)
def _sigmoid(x):
    return torch.sigmoid(x)
def _layernorm(x, axis=-1, eps=1e-5):
    m = x.mean(dim=axis, keepdim=True)
    v = x.var(dim=axis, keepdim=True, unbiased=False)
    return (x - m) / torch.sqrt(v + eps)
def _scatter_add(tgt, idx, src, axis=0):
    return tgt.clone().index_add_(axis, idx, src)
def _segment_sum(src, seg, n):
    out = torch.zeros((n,) + src.shape[1:], dtype=src.dtype)
    return out.index_add_(0, seg, src)
def _pad(x, pw):
    flat = tuple(v for pair in reversed(pw) for v in pair)
    return torch.nn.functional.pad(x, flat)

kernel_name = 'parallel_sum__ssm_conv_s5__dense_activation_silu__prompt'

def setup_inputs():

    _w = (lambda a: (lambda t: t.to(torch.bfloat16) if t.is_floating_point() else t)(torch.as_tensor(a)))
    def _A_setup():
        B, S, D = 1, 2048, 512
        P = D
        Lambda_re = -0.5 * (lambda _x: torch.exp(torch.as_tensor(_x)))((lambda *s: torch.randn(*s, dtype=torch.bfloat16) * 0.2)(P))
        Lambda_im = (lambda *s: torch.randn(*s, dtype=torch.bfloat16) * 0.8)(P) * 1.0
        B_re = (lambda *s: torch.randn(*s, dtype=torch.bfloat16) * 0.2)(P, D) * (D ** -0.5)
        B_im = (lambda *s: torch.randn(*s, dtype=torch.bfloat16) * 0.2)(P, D) * (D ** -0.5)
        C_re = (lambda *s: torch.randn(*s, dtype=torch.bfloat16) * 0.2)(D, P) * (P ** -0.5)
        C_im = (lambda *s: torch.randn(*s, dtype=torch.bfloat16) * 0.2)(D, P) * (P ** -0.5)
        log_dt = (lambda *s: torch.randn(*s, dtype=torch.bfloat16) * 0.2)(P) * 0.3 - 2.0
        Dskip = (lambda *s: torch.randn(*s, dtype=torch.bfloat16) * 0.05)(D)
        return {
            "x": _w((lambda *s: torch.randn(*s, dtype=torch.bfloat16) * 0.05)(B, S, D)),
            "Lambda_re": _w(Lambda_re),
            "Lambda_im": _w(Lambda_im),
            "B_re": _w(B_re),
            "B_im": _w(B_im),
            "C_re": _w(C_re),
            "C_im": _w(C_im),
            "log_dt": _w(log_dt),
            "Dskip": _w(Dskip),
        }
    _A_in = _A_setup()

    def _B_setup():
        B, S, D, F = 1, 2048, 512, 1792
        return {
            "x": _w((lambda *s: torch.randn(*s, dtype=torch.bfloat16) * 0.05)(B, S, D)),
            "w1": _w((lambda *s: torch.randn(*s, dtype=torch.bfloat16) * 0.8)(D, F) * (D ** -0.5)),
            "w2": _w((lambda *s: torch.randn(*s, dtype=torch.bfloat16) * 0.2)(F, D) * (F ** -0.5)),
        }
    _B_in = _B_setup()

    return {
        "A_x": _A_in["x"],
        "A_Lambda_re": _A_in["Lambda_re"],
        "A_Lambda_im": _A_in["Lambda_im"],
        "A_B_re": _A_in["B_re"],
        "A_B_im": _A_in["B_im"],
        "A_C_re": _A_in["C_re"],
        "A_C_im": _A_in["C_im"],
        "A_log_dt": _A_in["log_dt"],
        "A_Dskip": _A_in["Dskip"],
        "B_x": _B_in["x"],
        "B_w1": _B_in["w1"],
        "B_w2": _B_in["w2"],
    }

def reference(A_x, A_Lambda_re, A_Lambda_im, A_B_re, A_B_im, A_C_re, A_C_im, A_log_dt, A_Dskip, B_x, B_w1, B_w2):
    def _A_ref(x, Lambda_re, Lambda_im, B_re, B_im, C_re, C_im, log_dt, Dskip):
        Bsz, L, H = x.shape
        Lam = Lambda_re + 1j * Lambda_im
        Bmat = B_re + 1j * B_im
        Cmat = C_re + 1j * C_im
        dt = torch.exp(log_dt)
        Lam_bar = torch.exp(dt * Lam)
        B_bar = ((Lam_bar - 1.0) / Lam)[:, None] * Bmat
        Bu = torch.einsum("bld,pd->blp", x + 0j, B_bar)
        h = torch.zeros_like(Bu[:, 0, :])
        hs = []
        for t in range(L):
            h = Lam_bar[None, :] * h + Bu[:, t, :]
            hs.append(h)
        hseq = torch.stack(hs, 1)
        y = 2.0 * torch.einsum("blp,dp->bld", hseq, Cmat).real + x * Dskip[None, None, :]
        return y

    def _B_ref(x, w1, w2):
        h = torch.einsum("bsd,df->bsf", x, w1)
        h = _silu(h)
        out = torch.einsum("bsf,fd->bsd", h, w2)
        return out

    x = A_x
    xn = _layernorm(x, axis=-1)
    return x + _A_ref(xn, A_Lambda_re, A_Lambda_im, A_B_re, A_B_im, A_C_re, A_C_im, A_log_dt, A_Dskip) + _B_ref(xn, B_w1, B_w2)
```

```asm
; @launch grid=(256,1,1) block=(512,1,1) lds=163840
.amdgcn_target "amdgcn-amd-amdhsa--gfx950"
.text
.p2align 12
.fill 832, 4, 0xbf810000
.globl parallel_sum__ssm_conv_s5__dense_activation_silu__prompt_kernel
.p2align 8
.type parallel_sum__ssm_conv_s5__dense_activation_silu__prompt_kernel,@function
parallel_sum__ssm_conv_s5__dense_activation_silu__prompt_kernel:
  s_cmp_ge_u32 s2, 256
  s_cbranch_scc1 L_exit
  s_load_dwordx2 s[32:33], s[0:1], 0
  s_load_dwordx2 s[36:37], s[0:1], 80
  v_lshrrev_b32 v1, 6, v0
  v_lshrrev_b32_e64 v2, 4, v0
  v_readfirstlane_b32 s80, v1
  s_and_b32 s30, s2, 1
  v_xor_b32 v2, v2, v0
  s_lshr_b32 s83, s2, 5
  v_and_b32 v2, 7, v2
  s_lshl3_add_u32 s83, s30, s83
  v_and_b32 v3, 0x1f8, v0
  s_bfe_u32 s84, s2, 0x20001
  v_lshl_add_u32 v2, v3, 3, v2
  s_bfe_u32 s85, s2, 0x20003
  s_lshl_b32 s30, s83, 17
  v_lshrrev_b32 v4, 2, v0
  v_lshl_add_u32 v24, v2, 4, s30
  s_lshl_b32 s64, s83, 7
  v_and_b32 v4, 4, v4
  s_mul_i32 s31, s84, 7
  v_xor_b32 v4, v4, v0
  s_lshl1_add_u32 s31, s85, s31
  v_and_b32 v4, 7, v4
  s_lshl_b32 s31, s31, 7
  v_mul_u32_u24 v5, 448, v3
  s_and_b32 s64, s64, 0x380
  s_mul_i32 s72, s64, 1792
  v_lshl_add_u32 v6, v4, 4, s31
  s_lshl_b32 s89, s80, 10
  s_mov_b32 s34, 2097152
  s_mov_b32 s35, 0x20000
  v_add_u32 v26, v5, v6
  s_mov_b32 s38, 1835008
  s_mov_b32 s39, 0x20000
  v_add_u32 v25, 0x10000, v24
  s_add_u32 m0, s89, 131072
  s_waitcnt lgkmcnt(0)
  buffer_load_dwordx4 v24, s[32:35], s64 offen lds
  s_add_u32 s65, s64, 128
  s_and_b32 s65, s65, 0x380
  s_mul_i32 s73, s65, 1792
  s_load_dwordx4 s[4:7], s[0:1], 8
  s_load_dwordx4 s[8:11], s[0:1], 56
  s_load_dwordx2 s[56:57], s[0:1], 112
  s_and_b32 s81, s80, 3
  s_lshr_b32 s82, s80, 2
  v_and_b32_e64 v52, 63, v0
  v_lshlrev_b32 v55, 4, v52
  s_add_u32 s66, s65, 128
  s_and_b32 s66, s66, 0x380
  s_add_u32 m0, s89, 16384
  s_nop 0
  buffer_load_dwordx4 v26, s[36:39], s72 offen lds
  s_mul_i32 s74, s66, 1792
  s_lshl2_add_u32 s86, s84, s85
  s_lshl3_add_u32 s30, s82, 24
  s_load_dwordx2 s[40:41], s[0:1], s30
  s_load_dwordx2 s[44:45], s[0:1], 88
  s_load_dwordx2 s[48:49], s[0:1], 40
  s_load_dwordx2 s[52:53], s[0:1], 48
  s_load_dwordx2 s[60:61], s[0:1], 96
  s_mov_b32 s94, s2
  s_and_b32 s30, s2, 1
  s_lshl2_add_u32 s30, s30, s84
  s_lshr_b32 s87, s2, 6
  s_add_u32 m0, s89, 139264
  s_nop 0
  buffer_load_dwordx4 v25, s[32:35], s64 offen lds
  s_lshl2_add_u32 s87, s30, s87
  s_bfe_u32 s88, s2, 0x30003
  v_bfe_u32 v8, v0, 4, 1
  v_and_b32_e64 v7, 7, v0
  v_lshl_add_u32 v7, v8, 3, v7
  s_lshl1_add_u32 s31, s86, s82
  s_lshl_b32 s31, s31, 5
  v_lshl_add_u32 v7, v7, 1, s31
  s_waitcnt lgkmcnt(0)
  s_load_dwordx2 s[96:97], s[56:57], 0
  s_lshl_b32 s30, s82, 1
  s_xor_b32 s3, s30, s81
  s_lshl_b32 s98, s3, 1
  s_add_u32 m0, s89, 147456
  s_nop 0
  buffer_load_dwordx4 v24, s[32:35], s65 offen lds
  v_and_b32 v9, 3, v0
  v_bfe_u32 v10, v0, 3, 2
  v_lshl_add_u32 v10, v10, 2, v9
  v_bfe_u32 v11, v0, 2, 1
  v_lshl_add_u32 v54, v11, 4, v10
  v_bfe_u32 v13, v0, 5, 1
  v_xor_b32_e64 v10, s98, v13
  v_bfe_u32 v11, v54, 1, 3
  v_xor_b32_e64 v10, v10, v11
  v_lshl_add_u32 v10, v54, 3, v10
  s_lshl_b32 s30, s81, 12
  s_add_u32 s30, s30, 98304
  s_add_u32 m0, s89, 8192
  s_nop 0
  buffer_load_dwordx4 v26, s[36:39], s73 offen lds
  v_lshl_add_u32 v29, v10, 4, s30
  v_xor_b32 v30, 32, v29
  v_xor_b32 v31, 64, v29
  v_xor_b32 v32, 96, v29
  v_lshl_add_u32 v9, v8, 2, v9
  v_bfe_u32 v10, v0, 3, 1
  v_xor_b32_e64 v10, s82, v10
  v_lshl_add_u32 v9, v10, 3, v9
  v_bfe_u32 v10, v0, 2, 2
  v_lshl_add_u32 v9, v10, 4, v9
  v_lshl_add_u32 v9, v13, 7, v9
  s_add_u32 m0, s89, 155648
  s_nop 0
  buffer_load_dwordx4 v25, s[32:35], s65 offen lds
  s_lshl_b32 s30, s3, 11
  s_add_u32 s30, s30, 8192
  v_lshl_add_u32 v33, v9, 3, s30
  v_xor_b32 v34, 2048, v33
  v_xor_b32 v35, 4096, v33
  v_xor_b32 v36, 6144, v33
  s_add_u32 s67, s66, 128
  s_and_b32 s67, s67, 0x380
  s_mul_i32 s75, s67, 1792
  s_add_u32 s68, s67, 128
  s_and_b32 s68, s68, 0x380
  s_mul_i32 s76, s68, 1792
  s_add_u32 m0, s89, 106496
  s_nop 0
  buffer_load_dwordx4 v24, s[32:35], s66 offen lds
  v_lshl_add_u32 v3, v3, 3, v4
  s_lshl_b32 s30, s88, 7
  v_lshl_add_u32 v28, v3, 4, s30
  v_and_b32 v2, 0x7ff, v2
  s_lshl_b32 s30, s86, 15
  v_lshl_add_u32 v27, v2, 4, s30
  v_bfe_u32 v9, v0, 2, 1
  v_cmp_eq_u32 vcc, v8, v9
  s_mov_b32 s101, 0x3f803f80
  v_mov_b32 v9, s101
  v_cndmask_b32 v9, 0, v9, vcc
  v_mov_b32 v50, 0
  s_add_u32 m0, s89, 122880
  s_nop 0
  buffer_load_dwordx4 v26, s[36:39], s74 offen lds
  v_mov_b32_e64 v51, 0
  v_accvgpr_write_b32 a36, v9
  v_accvgpr_write_b32 a37, v9
  v_accvgpr_write_b32 a38, v9
  v_accvgpr_write_b32 a39, v9
  v_lshl_add_u32 v9, v13, 5, v54
  v_lshlrev_b32_e64 v37, 4, v9
  v_and_b32 v9, 31, v0
  v_lshl_add_u32 v10, v9, 1, v13
  s_lshl_b32 s30, s82, 9
  v_lshl_add_u32 v38, v10, 3, s30
  s_lshl_b32 s30, s81, 10
  s_add_u32 m0, s89, 114688
  s_nop 0
  buffer_load_dwordx4 v25, s[32:35], s66 offen lds
  s_add_u32 s30, s30, 4096
  v_lshl_add_u32 v49, v9, 5, s30
  s_add_u32 s69, s68, 128
  s_and_b32 s69, s69, 0x380
  s_mul_i32 s77, s69, 1792
  s_add_u32 s70, s69, 128
  s_and_b32 s70, s70, 0x380
  s_mul_i32 s78, s70, 1792
  s_add_u32 s71, s70, 128
  s_and_b32 s71, s71, 0x380
  s_mul_i32 s79, s71, 1792
  s_waitcnt vmcnt(6) lgkmcnt(0)
  s_barrier
  ds_read_b128 v[88:91], v29 offset:32768
  ds_read_b64_tr_b16 a[0:1], v33 offset:8192
  global_load_ushort v41, v7, s[4:5]
  global_load_ushort v42, v7, s[6:7]
  global_load_ushort v39, v7, s[8:9]
  ds_read_b64_tr_b16 a[2:3], v33 offset:8704
  ds_read_b128 v[92:95], v30 offset:32768
  ds_read_b64_tr_b16 a[4:5], v34 offset:8192
  ds_read_b64_tr_b16 a[6:7], v34 offset:8704
  s_sub_u32 s30, s86, s80
  s_lshl_b32 s30, s30, 13
  v_add_u32 v21, s30, v24
  s_lshl_b32 s30, s80, 7
  s_add_u32 s30, s30, s66
  s_add_u32 s30, s30, 128
  s_and_b32 s30, s30, 0x380
  s_mov_b32 m0, 2048
  s_nop 0
  buffer_load_dwordx4 v21, s[32:35], s30 offen lds
  ds_read_b128 v[96:99], v31 offset:32768
  ds_read_b64_tr_b16 a[8:9], v35 offset:8192
  ds_read_b64_tr_b16 a[10:11], v35 offset:8704
  ds_read_b128 v[100:103], v32 offset:32768
  s_add_u32 m0, s89, 73728
  ds_read_b64_tr_b16 a[12:13], v36 offset:8192
  buffer_load_dwordx4 v24, s[32:35], s67 offen lds
  ds_read_b64_tr_b16 a[14:15], v36 offset:8704
  s_mov_b32 s42, 524288
  s_mov_b32 s43, 0x20000
  s_mov_b64 s[50:51], s[42:43]
  s_mov_b64 s[54:55], s[42:43]
  s_mov_b64 s[46:47], s[38:39]
  s_mov_b32 s58, 12058624
  s_mov_b32 s59, 0x20000
  s_mov_b32 s62, 4194304
  s_mov_b32 s63, 0x20000
  s_lshl_b32 s99, s81, 2
  s_waitcnt lgkmcnt(9)
  v_mfma_f32_16x16x32_bf16 a[32:35], a[36:39], a[0:3], 0
  v_dot2_f32_bf16 v50, v88, s101, v50
  s_add_u32 m0, s89, 90112
  v_dot2_f32_bf16 v51, v88, v88, v51
  buffer_load_dwordx4 v26, s[36:39], s75 offen lds
  v_dot2_f32_bf16 v50, v89, s101, v50
  v_dot2_f32_bf16 v51, v89, v89, v51
  v_dot2_f32_bf16 v50, v90, s101, v50
  v_dot2_f32_bf16 v51, v90, v90, v51
  s_add_u32 m0, s89, 81920
  v_dot2_f32_bf16 v50, v91, s101, v50
  buffer_load_dwordx4 v25, s[32:35], s67 offen lds
  v_dot2_f32_bf16 v51, v91, v91, v51
  s_waitcnt lgkmcnt(8)
  v_dot2_f32_bf16 v50, v92, s101, v50
  v_dot2_f32_bf16 v51, v92, v92, v51
  v_dot2_f32_bf16 v50, v93, s101, v50
  v_dot2_f32_bf16 v51, v93, v93, v51
  v_dot2_f32_bf16 v50, v94, s101, v50
  v_dot2_f32_bf16 v51, v94, v94, v51
  v_dot2_f32_bf16 v50, v95, s101, v50
  v_dot2_f32_bf16 v51, v95, v95, v51
  s_waitcnt vmcnt(10) lgkmcnt(0)
  s_barrier
  v_mfma_f32_32x32x16_bf16 v[56:71], a[0:3], v[88:91], 0
  s_add_u32 m0, s89, 57344
  ds_read_b128 v[104:107], v29 offset:49152
  buffer_load_dwordx4 v24, s[32:35], s68 offen lds
  ds_read_b64_tr_b16 a[16:17], v33 offset:0
  ds_read_b64_tr_b16 a[18:19], v33 offset:512
  ds_read_b128 v[108:111], v30 offset:49152
  v_mfma_f32_32x32x16_bf16 v[56:71], a[4:7], v[92:95], v[56:71]
  ds_read_b64_tr_b16 a[20:21], v34 offset:0
  ds_read_b64_tr_b16 a[22:23], v34 offset:512
  ds_read_b128 v[112:115], v31 offset:49152
  ds_read_b64_tr_b16 a[24:25], v35 offset:0
  v_mfma_f32_32x32x16_bf16 v[56:71], a[8:11], v[96:99], v[56:71]
  ds_read_b64_tr_b16 a[26:27], v35 offset:512
  ds_read_b128 v[116:119], v32 offset:49152
  ds_read_b64_tr_b16 a[28:29], v36 offset:0
  ds_read_b64_tr_b16 a[30:31], v36 offset:512
  v_mfma_f32_32x32x16_bf16 v[56:71], a[12:15], v[100:103], v[56:71]
  s_waitcnt vmcnt(5)
  v_lshlrev_b32 v0, 16, v39
  s_add_u32 m0, s89, 49152
  v_lshlrev_b32_e64 v41, 16, v41
  buffer_load_dwordx4 v26, s[36:39], s76 offen lds
  v_mul_f32 v0, 0x3fb8aa3b, v0
  v_lshlrev_b32 v42, 16, v42
  v_exp_f32 v0, v0
  v_mul_f32_e64 v5, v41, v41
  v_cvt_pk_bf16_f32 v0, v0, v0
  v_lshlrev_b32_e64 v0, 16, v0
  v_fma_f32 v5, v42, v42, v5
  v_mul_f32 v1, v0, v41
  v_mul_f32 v2, v0, v42
  v_mul_f32 v1, 0x3fb8aa3b, v1
  v_mul_f32 v2, 0.15915494, v2
  v_exp_f32 v1, v1
  v_rndne_f32 v3, v2
  v_rcp_f32 v5, v5
  v_sub_f32_e64 v2, v2, v3
  s_add_u32 m0, s89, 65536
  v_cos_f32_e64 v3, v2
  buffer_load_dwordx4 v25, s[32:35], s68 offen lds
  v_sin_f32 v4, v2
  v_and_b32 v9, 8, v52
  v_mul_f32 v39, v1, v3
  v_mul_f32 v4, v1, v4
  v_add_f32 v6, -1.0, v39
  v_mul_f32 v7, v6, v41
  v_fma_f32 v7, v4, v42, v7
  v_mul_f32_e64 v8, v4, v41
  v_fma_f32 v8, -v6, v42, v8
  v_add_f32 v5, v5, v5
  v_mul_f32 v7, v7, v5
  v_mul_f32 v42, -v8, v5
  v_lshlrev_b32 v9, 28, v9
  v_xor_b32 v41, v7, v9
  v_xor_b32 v9, 0x80000000, v9
  v_xor_b32_e64 v40, v4, v9
  s_add_u32 m0, s89, 32768
  v_mul_f32_e64 v10, v40, v40
  buffer_load_dwordx4 v24, s[32:35], s69 offen lds
  v_mul_f32_e64 v1, v39, v40
  v_fma_f32 v0, v39, v39, -v10
  v_add_f32 v1, v1, v1
  v_mul_f32 v10, v1, v1
  v_mul_f32_e64 v3, v0, v1
  v_fma_f32 v2, v0, v0, -v10
  v_add_f32 v3, v3, v3
  v_mul_f32 v10, v3, v3
  v_mul_f32_e64 v1, v2, v3
  v_fma_f32 v0, v2, v2, -v10
  v_add_f32 v1, v1, v1
  v_mul_f32 v10, v1, v1
  v_mul_f32_e64 v44, v0, v1
  v_fma_f32 v43, v0, v0, -v10
  v_add_f32_e64 v44, v44, v44
  s_add_u32 m0, s89, 24576
  v_mul_f32_e64 v10, v44, v44
  buffer_load_dwordx4 v26, s[36:39], s77 offen lds
  v_mul_f32_e64 v1, v43, v44
  v_fma_f32 v0, v43, v43, -v10
  v_add_f32 v1, v1, v1
  v_mul_f32 v10, v1, v1
  v_mul_f32_e64 v3, v0, v1
  v_fma_f32 v2, v0, v0, -v10
  v_add_f32 v3, v3, v3
  v_mul_f32 v10, v3, v3
  v_mul_f32_e64 v48, v2, v3
  v_fma_f32 v47, v2, v2, -v10
  v_add_f32 v48, v48, v48
  v_cmp_lt_u32 vcc, 31, v52
  s_nop 1
  v_cndmask_b32 v45, 1.0, v43, vcc
  v_cndmask_b32 v46, 0, v44, vcc
  s_bitcmp1_b32 s81, 0
  s_cselect_b64 vcc, -1, 0
  v_cndmask_b32 v4, 1.0, v0, vcc
  s_add_u32 m0, s89, 40960
  v_cndmask_b32_e64 v5, 0, v1, vcc
  buffer_load_dwordx4 v25, s[32:35], s69 offen lds
  v_mul_f32 v6, v46, v5
  v_mul_f32 v7, v45, v5
  v_fma_f32 v46, v46, v4, v7
  v_fma_f32 v45, v45, v4, -v6
  s_bitcmp1_b32 s81, 1
  s_cselect_b64 vcc, -1, 0
  v_cndmask_b32 v4, 1.0, v2, vcc
  v_cndmask_b32 v5, 0, v3, vcc
  v_mul_f32 v6, v46, v5
  v_mul_f32 v7, v45, v5
  v_fma_f32 v46, v46, v4, v7
  v_fma_f32 v45, v45, v4, -v6
  v_and_b32_e64 v11, 7, v52
  v_bfe_u32 v12, v52, 4, 1
  v_lshl_add_u32 v11, v12, 3, v11
  v_bfe_u32 v12, v11, 1, 3
  v_bfe_u32 v13, v52, 3, 1
  v_lshl_add_u32 v11, v13, 5, v11
  v_lshrrev_b32 v13, 5, v52
  v_xor_b32 v13, s98, v13
  v_xor_b32 v12, v12, v13
  v_lshl_add_u32 v11, v11, 3, v12
  s_lshl_b32 s30, s82, 11
  s_add_u32 s30, s30, 65536
  v_lshl_add_u32 v20, v11, 4, s30
  v_lshrrev_b32 v11, 5, v52
  v_lshl_add_u32 v11, s82, 1, v11
  v_lshl_add_u32 v21, v11, 3, v49
  s_waitcnt lgkmcnt(9)
  v_mfma_f32_16x16x32_bf16 a[32:35], a[36:39], a[16:19], a[32:35]
  v_dot2_f32_bf16 v50, v104, s101, v50
  v_dot2_f32_bf16 v51, v104, v104, v51
  v_dot2_f32_bf16 v50, v105, s101, v50
  v_dot2_f32_bf16 v51, v105, v105, v51
  v_dot2_f32_bf16 v50, v106, s101, v50
  v_dot2_f32_bf16 v51, v106, v106, v51
  v_dot2_f32_bf16 v50, v107, s101, v50
  v_dot2_f32_bf16 v51, v107, v107, v51
  s_waitcnt lgkmcnt(8)
  v_dot2_f32_bf16 v50, v108, s101, v50
  v_dot2_f32_bf16 v51, v108, v108, v51
  v_dot2_f32_bf16 v50, v109, s101, v50
  v_dot2_f32_bf16 v51, v109, v109, v51
  v_dot2_f32_bf16 v50, v110, s101, v50
  v_dot2_f32_bf16 v51, v110, v110, v51
  v_dot2_f32_bf16 v50, v111, s101, v50
  v_dot2_f32_bf16 v51, v111, v111, v51
  s_waitcnt lgkmcnt(0)
  s_barrier
  v_mfma_f32_32x32x16_bf16 v[56:71], a[16:19], v[104:107], v[56:71]
  s_add_u32 s96, s96, 1
  s_add_u32 m0, s89, 131072
  v_add_u32 v33, 0xe000, v33
  buffer_load_dwordx4 v24, s[32:35], s70 offen lds
  v_add_u32 v34, 0xe000, v34
  v_add_u32 v35, 0xe000, v35
  v_add_u32 v36, 0xe000, v36
  s_add_u32 m0, s89, 16384
  ds_read_b128 v[120:123], v29 offset:8192
  buffer_load_dwordx4 v26, s[36:39], s78 offen lds
  ds_read_b64_tr_b16 a[0:1], v33 offset:57344
  v_mfma_f32_32x32x16_bf16 v[56:71], a[20:23], v[108:111], v[56:71]
  s_add_u32 s97, s97, 1
  ds_read_b64_tr_b16 a[2:3], v33 offset:57856
  ds_read_b128 v[124:127], v30 offset:8192
  s_add_u32 m0, s89, 139264
  ds_read_b64_tr_b16 a[4:5], v34 offset:57344
  buffer_load_dwordx4 v25, s[32:35], s70 offen lds
  ds_read_b64_tr_b16 a[6:7], v34 offset:57856
  ds_read_b128 v[128:131], v31 offset:8192
  v_mfma_f32_32x32x16_bf16 v[56:71], a[24:27], v[112:115], v[56:71]
  s_and_b32 s100, s87, 3
  ds_read_b64_tr_b16 a[8:9], v35 offset:57344
  s_add_u32 m0, s89, 147456
  ds_read_b64_tr_b16 a[10:11], v35 offset:57856
  buffer_load_dwordx4 v24, s[32:35], s71 offen lds
  ds_read_b128 v[132:135], v32 offset:8192
  ds_read_b64_tr_b16 a[12:13], v36 offset:57344
  ds_read_b64_tr_b16 a[14:15], v36 offset:57856
  v_mfma_f32_32x32x16_bf16 v[56:71], a[28:31], v[116:119], v[56:71]
  s_lshl_b32 s100, s100, 8
  s_add_u32 m0, s89, 8192
  s_waitcnt lgkmcnt(9)
  v_mfma_f32_16x16x32_bf16 a[32:35], a[36:39], a[0:3], a[32:35]
  buffer_load_dwordx4 v26, s[36:39], s79 offen lds
  v_dot2_f32_bf16 v50, v120, s101, v50
  v_dot2_f32_bf16 v51, v120, v120, v51
  v_dot2_f32_bf16 v50, v121, s101, v50
  v_dot2_f32_bf16 v51, v121, v121, v51
  s_add_u32 m0, s89, 155648
  v_dot2_f32_bf16 v50, v122, s101, v50
  buffer_load_dwordx4 v25, s[32:35], s71 offen lds
  v_dot2_f32_bf16 v51, v122, v122, v51
  v_dot2_f32_bf16 v50, v123, s101, v50
  v_dot2_f32_bf16 v51, v123, v123, v51
  s_waitcnt lgkmcnt(8)
  v_dot2_f32_bf16 v50, v124, s101, v50
  v_dot2_f32_bf16 v51, v124, v124, v51
  v_dot2_f32_bf16 v50, v125, s101, v50
  v_dot2_f32_bf16 v51, v125, v125, v51
  v_dot2_f32_bf16 v50, v126, s101, v50
  v_dot2_f32_bf16 v51, v126, v126, v51
  v_dot2_f32_bf16 v50, v127, s101, v50
  v_dot2_f32_bf16 v51, v127, v127, v51
  s_waitcnt vmcnt(12) lgkmcnt(0)
  s_barrier
  v_mfma_f32_32x32x16_bf16 v[56:71], a[0:3], v[120:123], v[56:71]
  s_lshr_b32 s91, s81, 1
  s_lshl1_add_u32 s91, s83, s91
  s_mul_i32 s91, s91, 352
  s_and_b32 s90, s81, 1
  v_add_u32 v29, 0xfffee000, v29
  s_cmp_eq_u32 s80, 7
  s_cbranch_scc1 Ltw_1
  s_mul_i32 s30, s94, 7
  s_add_u32 s30, s30, s80
  s_lshl_b32 s30, s30, 10
  s_mov_b32 m0, 2048
  s_nop 0
  buffer_load_dwordx4 v55, s[44:47], s30 offen lds
Ltw_1:
  s_cmp_lg_u32 s80, 7
  s_cbranch_scc1 Ltk_2
  s_getpc_b64 s[12:13]
L_pc:
  s_lshl_b32 s30, s94, 7
  s_and_b32 s30, s30, 0x3c00
  s_min_u32 s30, s30, (L_end-L_pc-1024)&0xff80
  s_and_b32 s12, s12, 0xffffff80
  v_add_u32 v22, s30, v55
  s_mov_b32 m0, 2048
  s_nop 0
  global_load_lds_dwordx4 v22, s[12:13]
Ltk_2:
  v_add_u32 v30, 0xfffee000, v30
  v_add_u32 v31, 0xfffee000, v31
  v_add_u32 v32, 0xfffee000, v32
  ds_read_b128 v[136:139], v29 offset:49152
  ds_read_b64_tr_b16 a[16:17], v33 offset:24576
  v_mfma_f32_32x32x16_bf16 v[56:71], a[4:7], v[124:127], v[56:71]
  s_add_u32 s91, s91, s90
  s_mul_i32 s90, s84, 88
  s_add_u32 s91, s91, s90
  ds_read_b64_tr_b16 a[18:19], v33 offset:25088
  ds_read_b128 v[140:143], v30 offset:49152
  ds_read_b64_tr_b16 a[20:21], v34 offset:24576
  s_cmp_lg_u32 s80, 4
  s_cbranch_scc1 Lod_3
  v_lshl_add_u32 v22, s88, 7, v55
  s_mov_b32 m0, 3584
  s_mov_b64 exec, 0xff
  global_load_lds_dwordx4 v22, s[10:11]
  s_mov_b64 exec, -1
Lod_3:
  ds_read_b64_tr_b16 a[22:23], v34 offset:25088
  ds_read_b128 v[144:147], v31 offset:49152
  v_mfma_f32_32x32x16_bf16 v[56:71], a[8:11], v[128:131], v[56:71]
  s_add_u32 s91, s91, 512
  s_lshl1_add_u32 s90, s85, s82
  s_lshl2_add_u32 s90, s90, s91
  s_lshl_b32 s90, s90, 10
  ds_read_b64_tr_b16 a[24:25], v35 offset:24576
  ds_read_b64_tr_b16 a[26:27], v35 offset:25088
  ds_read_b128 v[148:151], v32 offset:49152
  ds_read_b64_tr_b16 a[28:29], v36 offset:24576
  ds_read_b64_tr_b16 a[30:31], v36 offset:25088
  v_mfma_f32_32x32x16_bf16 v[56:71], a[12:15], v[132:135], v[56:71]
  s_and_b32 s92, s85, 1
  s_lshl1_add_u32 s92, s92, s82
  s_lshl1_add_u32 s91, s92, s91
  s_add_u32 m0, s89, 98304
  s_waitcnt lgkmcnt(9)
  v_mfma_f32_16x16x32_bf16 a[32:35], a[36:39], a[16:19], a[32:35]
  buffer_load_dwordx4 v27, s[40:43], s64 offen lds
  v_dot2_f32_bf16 v50, v136, s101, v50
  v_dot2_f32_bf16 v51, v136, v136, v51
  v_dot2_f32_bf16 v50, v137, s101, v50
  v_dot2_f32_bf16 v51, v137, v137, v51
  v_dot2_f32_bf16 v50, v138, s101, v50
  v_dot2_f32_bf16 v51, v138, v138, v51
  v_dot2_f32_bf16 v50, v139, s101, v50
  v_dot2_f32_bf16 v51, v139, v139, v51
  s_waitcnt lgkmcnt(8)
  v_dot2_f32_bf16 v50, v140, s101, v50
  v_dot2_f32_bf16 v51, v140, v140, v51
  v_dot2_f32_bf16 v50, v141, s101, v50
  v_dot2_f32_bf16 v51, v141, v141, v51
  v_dot2_f32_bf16 v50, v142, s101, v50
  v_dot2_f32_bf16 v51, v142, v142, v51
  v_dot2_f32_bf16 v50, v143, s101, v50
  v_dot2_f32_bf16 v51, v143, v143, v51
  s_waitcnt vmcnt(11) lgkmcnt(0)
  s_barrier
  v_mfma_f32_32x32x16_bf16 v[56:71], a[16:19], v[136:139], v[56:71]
  s_and_b32 s92, s85, 2
  s_lshl3_add_u32 s91, s92, s91
  v_add_u32 v33, 0xffff2000, v33
  s_and_b32 s30, s80, 1
  s_lshl1_add_u32 s30, s94, s30
  s_lshl_b32 s30, s30, 10
  s_bitcmp1_b32 s80, 1
  s_cselect_b32 s30, 1048576, s30
  s_cmp_lg_u32 s82, 0
  s_cbranch_scc1 Ltc_4
  s_mov_b32 m0, 2048
  s_nop 0
  buffer_load_dwordx4 v55, s[48:51], s30 offen lds
Ltc_4:
  s_cmp_eq_u32 s82, 0
  s_cbranch_scc1 Ltd_5
  s_mov_b32 m0, 2048
  s_nop 0
  buffer_load_dwordx4 v55, s[52:55], s30 offen lds
Ltd_5:
  v_add_u32 v34, 0xffff2000, v34
  v_add_u32 v35, 0xffff2000, v35
  v_add_u32 v36, 0xffff2000, v36
  ds_read_b128 v[152:155], v29 offset:32768
  ds_read_b64_tr_b16 a[0:1], v33 offset:40960
  v_mfma_f32_32x32x16_bf16 v[56:71], a[20:23], v[140:143], v[56:71]
  s_add_u32 s91, s91, 56
  s_lshl_b32 s91, s91, 10
  ds_read_b64_tr_b16 a[2:3], v33 offset:41472
  ds_read_b128 v[156:159], v30 offset:32768
  ds_read_b64_tr_b16 a[4:5], v34 offset:40960
  ds_read_b64_tr_b16 a[6:7], v34 offset:41472
  ds_read_b128 v[160:163], v31 offset:32768
  v_mfma_f32_32x32x16_bf16 v[56:71], a[24:27], v[144:147], v[56:71]
  s_mul_i32 s92, s83, 12
  s_add_u32 s92, s92, s84
  ds_read_b64_tr_b16 a[8:9], v35 offset:40960
  s_add_u32 m0, s89, 106496
  ds_read_b64_tr_b16 a[10:11], v35 offset:41472
  buffer_load_dwordx4 v27, s[40:43], s65 offen lds
  ds_read_b128 v[164:167], v32 offset:32768
  ds_read_b64_tr_b16 a[12:13], v36 offset:40960
  ds_read_b64_tr_b16 a[14:15], v36 offset:41472
  v_mfma_f32_32x32x16_bf16 v[56:71], a[28:31], v[148:151], v[56:71]
  s_lshl4_add_u32 s92, s92, s85
  s_lshl3_add_u32 s92, s92, 4096
  s_waitcnt lgkmcnt(9)
  v_mfma_f32_16x16x32_bf16 a[32:35], a[36:39], a[0:3], a[32:35]
  v_dot2_f32_bf16 v50, v152, s101, v50
  v_dot2_f32_bf16 v51, v152, v152, v51
  v_dot2_f32_bf16 v50, v153, s101, v50
  v_dot2_f32_bf16 v51, v153, v153, v51
  v_dot2_f32_bf16 v50, v154, s101, v50
  v_dot2_f32_bf16 v51, v154, v154, v51
  v_dot2_f32_bf16 v50, v155, s101, v50
  v_dot2_f32_bf16 v51, v155, v155, v51
  s_waitcnt lgkmcnt(8)
  v_dot2_f32_bf16 v50, v156, s101, v50
  v_dot2_f32_bf16 v51, v156, v156, v51
  v_dot2_f32_bf16 v50, v157, s101, v50
  v_dot2_f32_bf16 v51, v157, v157, v51
  v_dot2_f32_bf16 v50, v158, s101, v50
  v_dot2_f32_bf16 v51, v158, v158, v51
  v_dot2_f32_bf16 v50, v159, s101, v50
  v_dot2_f32_bf16 v51, v159, v159, v51
  s_waitcnt vmcnt(10) lgkmcnt(0)
  s_barrier
  v_mfma_f32_32x32x16_bf16 v[56:71], a[0:3], v[152:155], v[56:71]
  s_lshl_b32 s20, s87, 13
  s_mov_b32 s24, 0
  s_and_b32 s20, s20, 0x6000
  s_and_b32 s24, s24, 0x6000
  s_add_u32 s21, s20, 8192
  s_add_u32 s25, s24, 8192
  s_add_u32 m0, s89, 114688
  ds_read_b128 v[168:171], v29 offset:8192
  buffer_load_dwordx4 v27, s[40:43], s66 offen lds
  ds_read_b64_tr_b16 a[16:17], v33 offset:16384
  ds_read_b64_tr_b16 a[18:19], v33 offset:16896
  ds_read_b128 v[172:175], v30 offset:8192
  v_mfma_f32_32x32x16_bf16 v[56:71], a[4:7], v[156:159], v[56:71]
  s_and_b32 s21, s21, 0x6000
  s_and_b32 s25, s25, 0x6000
  s_add_u32 s22, s21, 8192
  s_add_u32 s26, s25, 8192
  s_and_b32 s22, s22, 0x6000
  s_and_b32 s26, s26, 0x6000
  ds_read_b64_tr_b16 a[20:21], v34 offset:16384
  ds_read_b64_tr_b16 a[22:23], v34 offset:16896
  ds_read_b128 v[176:179], v31 offset:8192
  ds_read_b64_tr_b16 a[24:25], v35 offset:16384
  v_mfma_f32_32x32x16_bf16 v[56:71], a[8:11], v[160:163], v[56:71]
  s_add_u32 s23, s22, 8192
  s_add_u32 s27, s26, 8192
  s_and_b32 s23, s23, 0x6000
  s_and_b32 s27, s27, 0x6000
  s_add_u32 s16, s20, s89
  s_mul_i32 s20, s20, 56
  ds_read_b64_tr_b16 a[26:27], v35 offset:16896
  ds_read_b128 v[180:183], v32 offset:8192
  ds_read_b64_tr_b16 a[28:29], v36 offset:16384
  ds_read_b64_tr_b16 a[30:31], v36 offset:16896
  v_mfma_f32_32x32x16_bf16 v[56:71], a[12:15], v[164:167], v[56:71]
  s_add_u32 s17, s21, s89
  s_mul_i32 s21, s21, 56
  s_add_u32 s18, s22, s89
  s_mul_i32 s22, s22, 56
  s_add_u32 s19, s23, s89
  s_mul_i32 s23, s23, 56
  s_waitcnt lgkmcnt(9)
  v_mfma_f32_16x16x32_bf16 a[32:35], a[36:39], a[16:19], a[32:35]
  v_dot2_f32_bf16 v50, v168, s101, v50
  v_dot2_f32_bf16 v51, v168, v168, v51
  v_dot2_f32_bf16 v50, v169, s101, v50
  v_dot2_f32_bf16 v51, v169, v169, v51
  v_dot2_f32_bf16 v50, v170, s101, v50
  v_dot2_f32_bf16 v51, v170, v170, v51
  v_dot2_f32_bf16 v50, v171, s101, v50
  v_dot2_f32_bf16 v51, v171, v171, v51
  s_waitcnt lgkmcnt(8)
  v_dot2_f32_bf16 v50, v172, s101, v50
  v_dot2_f32_bf16 v51, v172, v172, v51
  v_dot2_f32_bf16 v50, v173, s101, v50
  v_dot2_f32_bf16 v51, v173, v173, v51
  v_dot2_f32_bf16 v50, v174, s101, v50
  v_dot2_f32_bf16 v51, v174, v174, v51
  v_dot2_f32_bf16 v50, v175, s101, v50
  v_dot2_f32_bf16 v51, v175, v175, v51
  s_waitcnt vmcnt(8) lgkmcnt(0)
  s_barrier
  v_mfma_f32_32x32x16_bf16 v[56:71], a[16:19], v[168:171], v[56:71]
  s_add_u32 m0, s89, 122880
  v_add_u32 v29, 0x12000, v29
  buffer_load_dwordx4 v27, s[40:43], s67 offen lds
  v_add_u32 v30, 0x12000, v30
  v_add_u32 v31, 0x12000, v31
  v_add_u32 v32, 0x12000, v32
  ds_read_b128 v[184:187], v29 offset:32768
  ds_read_b64_tr_b16 a[0:1], v33 offset:8192
  v_mfma_f32_32x32x16_bf16 v[56:71], a[20:23], v[172:175], v[56:71]
  ds_read_b64_tr_b16 a[2:3], v33 offset:8704
  ds_read_b128 v[188:191], v30 offset:32768
  ds_read_b64_tr_b16 a[4:5], v34 offset:8192
  ds_read_b64_tr_b16 a[6:7], v34 offset:8704
  ds_read_b128 v[192:195], v31 offset:32768
  v_mfma_f32_32x32x16_bf16 v[56:71], a[24:27], v[176:179], v[56:71]
  ds_read_b64_tr_b16 a[8:9], v35 offset:8192
  ds_read_b64_tr_b16 a[10:11], v35 offset:8704
  ds_read_b128 v[196:199], v32 offset:32768
  ds_read_b64_tr_b16 a[12:13], v36 offset:8192
  ds_read_b64_tr_b16 a[14:15], v36 offset:8704
  v_mfma_f32_32x32x16_bf16 v[56:71], a[28:31], v[180:183], v[56:71]
  s_waitcnt lgkmcnt(9)
  v_mfma_f32_16x16x32_bf16 a[32:35], a[36:39], a[0:3], a[32:35]
  v_dot2_f32_bf16 v50, v184, s101, v50
  v_dot2_f32_bf16 v51, v184, v184, v51
  v_dot2_f32_bf16 v50, v185, s101, v50
  v_dot2_f32_bf16 v51, v185, v185, v51
  v_dot2_f32_bf16 v50, v186, s101, v50
  v_dot2_f32_bf16 v51, v186, v186, v51
  v_dot2_f32_bf16 v50, v187, s101, v50
  v_dot2_f32_bf16 v51, v187, v187, v51
  s_waitcnt lgkmcnt(8)
  v_dot2_f32_bf16 v50, v188, s101, v50
  v_dot2_f32_bf16 v51, v188, v188, v51
  v_dot2_f32_bf16 v50, v189, s101, v50
  v_dot2_f32_bf16 v51, v189, v189, v51
  v_dot2_f32_bf16 v50, v190, s101, v50
  v_dot2_f32_bf16 v51, v190, v190, v51
  v_dot2_f32_bf16 v50, v191, s101, v50
  v_dot2_f32_bf16 v51, v191, v191, v51
  s_waitcnt vmcnt(6) lgkmcnt(0)
  s_barrier
  v_mfma_f32_32x32x16_bf16 v[56:71], a[0:3], v[184:187], v[56:71]
  ds_read_b128 v[200:203], v29 offset:49152
  ds_read_b64_tr_b16 a[16:17], v33 offset:0
  ds_read_b64_tr_b16 a[18:19], v33 offset:512
  ds_read_b128 v[204:207], v30 offset:49152
  v_mfma_f32_32x32x16_bf16 v[56:71], a[4:7], v[188:191], v[56:71]
  ds_read_b64_tr_b16 a[20:21], v34 offset:0
  ds_read_b64_tr_b16 a[22:23], v34 offset:512
  ds_read_b128 v[208:211], v31 offset:49152
  ds_read_b64_tr_b16 a[24:25], v35 offset:0
  v_mfma_f32_32x32x16_bf16 v[56:71], a[8:11], v[192:195], v[56:71]
  ds_read_b64_tr_b16 a[26:27], v35 offset:512
  ds_read_b128 v[212:215], v32 offset:49152
  ds_read_b64_tr_b16 a[28:29], v36 offset:0
  ds_read_b64_tr_b16 a[30:31], v36 offset:512
  v_mfma_f32_32x32x16_bf16 v[56:71], a[12:15], v[196:199], v[56:71]
  s_waitcnt lgkmcnt(9)
  v_mfma_f32_16x16x32_bf16 a[32:35], a[36:39], a[16:19], a[32:35]
  v_dot2_f32_bf16 v50, v200, s101, v50
  v_dot2_f32_bf16 v51, v200, v200, v51
  v_dot2_f32_bf16 v50, v201, s101, v50
  v_dot2_f32_bf16 v51, v201, v201, v51
  v_dot2_f32_bf16 v50, v202, s101, v50
  v_dot2_f32_bf16 v51, v202, v202, v51
  v_dot2_f32_bf16 v50, v203, s101, v50
  v_dot2_f32_bf16 v51, v203, v203, v51
  s_waitcnt lgkmcnt(8)
  v_dot2_f32_bf16 v50, v204, s101, v50
  v_dot2_f32_bf16 v51, v204, v204, v51
  v_dot2_f32_bf16 v50, v205, s101, v50
  v_dot2_f32_bf16 v51, v205, v205, v51
  v_dot2_f32_bf16 v50, v206, s101, v50
  v_dot2_f32_bf16 v51, v206, v206, v51
  v_dot2_f32_bf16 v50, v207, s101, v50
  v_dot2_f32_bf16 v51, v207, v207, v51
  v_mov_b32 v29, v20
  v_xor_b32 v30, 32, v20
  v_xor_b32_e64 v31, 64, v20
  v_xor_b32 v32, 96, v20
  ds_write_b64 v21, v[50:51]
  v_and_or_b32 v23, v38, -9, s99
  ds_write_b32 v23, a32 offset:0
  s_waitcnt vmcnt(0) lgkmcnt(0)
  s_barrier
  ds_read_b128 v[0:3], v49
  ds_read_b128 v[4:7], v49 offset:16
  ds_read_b64 v[22:23], v38 offset:0
  ds_read_b128 a[0:3], v29 offset:32768
  ds_read_b128 a[4:7], v30 offset:32768
  ds_read_b128 a[8:11], v31 offset:32768
  ds_read_b128 a[12:15], v32 offset:32768
  s_add_u32 m0, s89, 73728
  v_mfma_f32_32x32x16_bf16 v[56:71], a[16:19], v[200:203], v[56:71]
  buffer_load_dwordx4 v27, s[40:43], s68 offen lds
  ds_read_b128 a[16:19], v29 offset:40960
  s_add_u32 m0, s89, 81920
  v_mfma_f32_32x32x16_bf16 v[56:71], a[20:23], v[204:207], v[56:71]
  buffer_load_dwordx4 v27, s[40:43], s69 offen lds
  s_waitcnt lgkmcnt(7)
  v_add_f32 v0, v0, v2
  s_waitcnt lgkmcnt(6)
  v_add_f32 v4, v4, v6
  v_add_f32 v1, v1, v3
  v_add_f32 v5, v5, v7
  v_add_f32_e64 v0, v0, v4
  ds_read_b128 a[20:23], v30 offset:40960
  s_add_u32 m0, s89, 90112
  v_mfma_f32_32x32x16_bf16 v[56:71], a[24:27], v[208:211], v[56:71]
  buffer_load_dwordx4 v27, s[40:43], s70 offen lds
  v_add_f32_e64 v1, v1, v5
  v_mul_f32 v0, 0x3b000000, v0
  v_mul_f32 v1, 0x3b000000, v1
  v_cvt_pk_bf16_f32 v2, v0, v0
  ds_read_b128 a[24:27], v31 offset:40960
  s_add_u32 m0, s89, 65536
  v_mfma_f32_32x32x16_bf16 v[56:71], a[28:31], v[212:215], v[56:71]
  buffer_load_dwordx4 v27, s[40:43], s71 offen lds
  v_lshlrev_b32_e64 v2, 16, v2
  v_fma_f32 v1, -v0, v0, v1
  v_xor_b32 v50, 0x80000000, v2
  s_waitcnt lgkmcnt(7)
  v_add_f32_e64 v22, v22, v23
  ds_read_b128 a[28:31], v32 offset:40960
  s_waitcnt lgkmcnt(6)
  v_mfma_f32_32x32x16_bf16 v[72:87], v[88:91], a[0:3], 0
  v_mfma_f32_16x16x32_bf16 a[32:35], a[36:39], a[0:3], 0
  ds_read_b128 a[0:3], v29 offset:49152
  s_cmp_eq_u32 s85, 3
  s_cselect_b32 s38, 0, s38
  s_add_u32 m0, s89, 57216
  v_mfma_f32_32x32x16_bf16 v[72:87], v[92:95], a[4:7], v[72:87]
  buffer_load_dwordx4 v26, s[36:39], s72 offen offset:128 lds
  v_mfma_f32_32x32x2_f32 v[56:71], v22, v50, v[56:71]
  ds_read_b128 a[4:7], v30 offset:49152
  s_waitcnt lgkmcnt(6)
  v_mfma_f32_32x32x16_bf16 v[72:87], v[96:99], a[8:11], v[72:87]
  v_max_f32 v1, 0, v1
  v_cvt_pk_bf16_f32 v1, v1, v1
  v_lshlrev_b32_e64 v1, 16, v1
  v_add_f32 v1, 0x3727c5ac, v1
  v_cvt_pk_bf16_f32 v1, v1, v1
  ds_read_b128 a[8:11], v31 offset:49152
  s_add_u32 m0, s89, 49024
  v_mfma_f32_32x32x16_bf16 v[72:87], v[100:103], a[12:15], v[72:87]
  buffer_load_dwordx4 v26, s[36:39], s73 offen offset:128 lds
  v_lshlrev_b32 v1, 16, v1
  v_sqrt_f32 v1, v1
  v_lshlrev_b32_e64 v4, 2, v54
  v_cvt_pk_bf16_f32 v51, v1, v1
  v_lshlrev_b32 v51, 16, v51
  ds_read_b128 a[12:15], v32 offset:49152
  s_waitcnt lgkmcnt(6)
  v_mfma_f32_32x32x16_bf16 v[72:87], v[104:107], a[16:19], v[72:87]
  v_rcp_f32_e64 v3, v51
  v_lshl_add_u32 v4, s80, 7, v4
  v_mul_f32 v49, 0xbfb8aa3b, v3
  ds_write_b32 v4, v3 offset:1024
  s_or_b32 s30, s86, s82
  s_cbranch_scc1 Lst_6
  s_lshl2_add_u32 s30, s83, s81
  s_lshl_b32 s30, s30, 8
  s_add_u32 s30, s30, 32768
  v_lshlrev_b32 v4, 3, v54
  s_mov_b32 exec_hi, 0
  buffer_store_dwordx2 v[2:3], v4, s[56:59], s30 offen sc1
  s_mov_b32 exec_hi, -1
Lst_6:
  v_mfma_f32_16x16x32_bf16 a[32:35], a[36:39], a[16:19], a[32:35]
  ds_read_b128 a[16:19], v29 offset:57344
  s_add_u32 m0, s89, 40832
  v_mfma_f32_32x32x16_bf16 v[72:87], v[108:111], a[20:23], v[72:87]
  buffer_load_dwordx4 v26, s[36:39], s74 offen offset:128 lds
  ds_read_b128 a[20:23], v30 offset:57344
  s_waitcnt lgkmcnt(7)
  v_mfma_f32_32x32x16_bf16 v[72:87], v[112:115], a[24:27], v[72:87]
  ds_read_b128 a[24:27], v31 offset:57344
  s_add_u32 m0, s89, 32640
  v_mfma_f32_32x32x16_bf16 v[72:87], v[116:119], a[28:31], v[72:87]
  buffer_load_dwordx4 v26, s[36:39], s75 offen offset:128 lds
  v_mul_f32 v8, v49, v56
  v_mul_f32 v9, v49, v57
  v_mul_f32 v10, v49, v58
  v_mul_f32 v11, v49, v59
  v_exp_f32 v8, v8
  ds_read_b128 a[28:31], v32 offset:57344
  s_waitcnt lgkmcnt(7)
  v_mfma_f32_32x32x16_bf16 v[72:87], v[120:123], a[0:3], v[72:87]
  v_exp_f32 v9, v9
  v_exp_f32 v10, v10
  v_exp_f32_e64 v11, v11
  v_fma_f32 v8, v8, v51, v51
  v_fma_f32 v9, v9, v51, v51
  v_mfma_f32_16x16x32_bf16 a[32:35], a[36:39], a[0:3], a[32:35]
  v_mfma_f32_32x32x16_bf16 v[72:87], v[124:127], a[4:7], v[72:87]
  s_lshl_b32 s30, s88, 16
  s_lshl_b32 s31, s83, 17
  s_sub_u32 s30, s30, s31
  v_add_u32 v27, s30, v24
  v_fma_f32 v10, v10, v51, v51
  v_fma_f32 v11, v11, v51, v51
  v_rcp_f32 v8, v8
  v_rcp_f32 v9, v9
  v_rcp_f32 v10, v10
  s_waitcnt lgkmcnt(5)
  v_mfma_f32_32x32x16_bf16 v[72:87], v[128:131], a[8:11], v[72:87]
  v_rcp_f32 v11, v11
  v_mul_f32 v56, v56, v8
  v_mul_f32 v57, v57, v9
  v_mul_f32 v58, v58, v10
  s_waitcnt vmcnt(4) lgkmcnt(0)
  s_barrier
  ds_read_b128 a[0:3], v29 offset:8192
  ds_read_b128 a[4:7], v30 offset:8192
  ds_read_b128 a[8:11], v31 offset:8192
  s_add_u32 m0, s89, 24448
  v_mfma_f32_32x32x16_bf16 v[72:87], v[132:135], a[12:15], v[72:87]
  buffer_load_dwordx4 v26, s[36:39], s76 offen offset:128 lds
  v_mul_f32_e64 v59, v59, v11
  v_cvt_pk_bf16_f32 v56, v56, v57
  v_cvt_pk_bf16_f32 v57, v58, v59
  v_mul_f32 v12, v49, v60
  v_mul_f32 v13, v49, v61
  ds_read_b128 a[12:15], v32 offset:8192
  v_mfma_f32_32x32x16_bf16 v[72:87], v[136:139], a[16:19], v[72:87]
  v_mul_f32 v14, v49, v62
  v_mul_f32 v15, v49, v63
  v_exp_f32 v12, v12
  v_exp_f32 v13, v13
  v_exp_f32_e64 v14, v14
  v_mfma_f32_16x16x32_bf16 a[32:35], a[36:39], a[16:19], a[32:35]
  ds_read_b128 a[16:19], v29 offset:16384
  s_add_u32 m0, s89, 16256
  v_mfma_f32_32x32x16_bf16 v[72:87], v[140:143], a[20:23], v[72:87]
  buffer_load_dwordx4 v26, s[36:39], s77 offen offset:128 lds
  v_exp_f32_e64 v15, v15
  v_fma_f32 v12, v12, v51, v51
  v_fma_f32 v13, v13, v51, v51
  v_fma_f32 v14, v14, v51, v51
  v_fma_f32 v15, v15, v51, v51
  ds_read_b128 a[20:23], v30 offset:16384
  v_mfma_f32_32x32x16_bf16 v[72:87], v[144:147], a[24:27], v[72:87]
  v_rcp_f32 v12, v12
  v_rcp_f32 v13, v13
  v_rcp_f32 v14, v14
  v_rcp_f32 v15, v15
  ds_read_b128 a[24:27], v31 offset:16384
  s_add_u32 m0, s89, 8064
  v_mfma_f32_32x32x16_bf16 v[72:87], v[148:151], a[28:31], v[72:87]
  buffer_load_dwordx4 v26, s[36:39], s78 offen offset:128 lds
  v_mul_f32 v60, v60, v12
  v_mul_f32 v61, v61, v13
  v_mul_f32_e64 v62, v62, v14
  v_mul_f32 v63, v63, v15
  v_cvt_pk_bf16_f32 v58, v60, v61
  ds_read_b128 a[28:31], v32 offset:16384
  s_waitcnt lgkmcnt(6)
  v_mfma_f32_32x32x16_bf16 v[72:87], v[152:155], a[0:3], v[72:87]
  v_cvt_pk_bf16_f32 v59, v62, v63
  buffer_store_dwordx4 v[56:59], v37, s[56:59], s90 offen offset:0 sc1
  v_mul_f32 v8, v49, v64
  v_mul_f32 v9, v49, v65
  v_mul_f32_e64 v10, v49, v66
  v_mfma_f32_16x16x32_bf16 a[32:35], a[36:39], a[0:3], a[32:35]
  ds_read_b128 a[0:3], v29 offset:24576
  s_add_u32 m0, s16, 131072
  s_lshl4_add_u32 s95, s24, s20
  v_mfma_f32_32x32x16_bf16 v[72:87], v[156:159], a[4:7], v[72:87]
  buffer_load_dwordx4 v28, s[44:47], s95 offen lds
  v_mul_f32 v11, v49, v67
  v_exp_f32 v8, v8
  v_exp_f32 v9, v9
  v_exp_f32_e64 v10, v10
  v_exp_f32 v11, v11
  ds_read_b128 a[4:7], v30 offset:24576
  s_waitcnt lgkmcnt(6)
  v_mfma_f32_32x32x16_bf16 v[72:87], v[160:163], a[8:11], v[72:87]
  v_fma_f32 v8, v8, v51, v51
  v_fma_f32 v9, v9, v51, v51
  v_fma_f32 v10, v10, v51, v51
  v_fma_f32 v11, v11, v51, v51
  ds_read_b128 a[8:11], v31 offset:24576
  s_add_u32 m0, s17, 131072
  s_lshl4_add_u32 s95, s24, s21
  v_mfma_f32_32x32x16_bf16 v[72:87], v[164:167], a[12:15], v[72:87]
  buffer_load_dwordx4 v28, s[44:47], s95 offen lds
  v_rcp_f32 v8, v8
  v_rcp_f32 v9, v9
  v_rcp_f32 v10, v10
  v_rcp_f32 v11, v11
  v_mul_f32 v64, v64, v8
  ds_read_b128 a[12:15], v32 offset:24576
  s_waitcnt lgkmcnt(6)
  v_mfma_f32_32x32x16_bf16 v[72:87], v[168:171], a[16:19], v[72:87]
  v_mul_f32 v65, v65, v9
  v_mul_f32 v66, v66, v10
  v_mul_f32 v67, v67, v11
  v_cvt_pk_bf16_f32 v64, v64, v65
  v_cvt_pk_bf16_f32 v65, v66, v67
  v_mfma_f32_16x16x32_bf16 a[32:35], a[36:39], a[16:19], a[32:35]
  ds_read_b128 a[16:19], v29 offset:0
  s_add_u32 m0, s18, 131072
  s_lshl4_add_u32 s95, s24, s22
  v_mfma_f32_32x32x16_bf16 v[72:87], v[172:175], a[20:23], v[72:87]
  buffer_load_dwordx4 v28, s[44:47], s95 offen lds
  v_mul_f32 v12, v49, v68
  v_mul_f32 v13, v49, v69
  v_mul_f32 v14, v49, v70
  v_mul_f32 v15, v49, v71
  v_exp_f32 v12, v12
  ds_read_b128 a[20:23], v30 offset:0
  s_waitcnt lgkmcnt(6)
  v_mfma_f32_32x32x16_bf16 v[72:87], v[176:179], a[24:27], v[72:87]
  v_exp_f32 v13, v13
  v_exp_f32_e64 v14, v14
  v_exp_f32 v15, v15
  v_fma_f32 v12, v12, v51, v51
  ds_read_b128 a[24:27], v31 offset:0
  s_add_u32 m0, s19, 131072
  s_lshl4_add_u32 s95, s24, s23
  v_mfma_f32_32x32x16_bf16 v[72:87], v[180:183], a[28:31], v[72:87]
  buffer_load_dwordx4 v28, s[44:47], s95 offen lds
  v_fma_f32 v13, v13, v51, v51
  v_fma_f32 v14, v14, v51, v51
  v_fma_f32 v15, v15, v51, v51
  v_rcp_f32 v12, v12
  v_rcp_f32 v13, v13
  ds_read_b128 a[28:31], v32 offset:0
  s_waitcnt lgkmcnt(6)
  v_mfma_f32_32x32x16_bf16 v[72:87], v[184:187], a[0:3], v[72:87]
  v_rcp_f32 v14, v14
  v_rcp_f32 v15, v15
  v_mul_f32 v68, v68, v12
  v_mul_f32 v69, v69, v13
  v_mul_f32 v70, v70, v14
  v_mfma_f32_16x16x32_bf16 a[32:35], a[36:39], a[0:3], a[32:35]
  s_add_u32 m0, s16, 98304
  s_lshl4_add_u32 s95, s25, s20
  v_mfma_f32_32x32x16_bf16 v[72:87], v[188:191], a[4:7], v[72:87]
  buffer_load_dwordx4 v28, s[44:47], s95 offen lds
  v_mul_f32 v71, v71, v15
  v_cvt_pk_bf16_f32 v66, v68, v69
  v_cvt_pk_bf16_f32 v67, v70, v71
  buffer_store_dwordx4 v[64:67], v37, s[56:59], s90 offen offset:2048 sc1
  s_waitcnt lgkmcnt(4)
  v_mfma_f32_32x32x16_bf16 v[72:87], v[192:195], a[8:11], v[72:87]
  s_lshr_b32 s93, s87, 1
  s_mul_i32 s93, s93, 12
  s_add_u32 s93, s93, s81
  s_lshl_b32 s93, s93, 7
  s_add_u32 s93, s93, 4096
  v_and_b32 v24, 7, v52
  v_and_b32_e64 v22, 1, v52
  v_lshl_add_u32 v24, v24, 2, s93
  v_cmp_eq_u32 vcc, 0, v22
  v_mov_b32 v22, s96
  v_mov_b32_e64 v23, s97
  v_cndmask_b32 v25, v23, v22, vcc
  s_add_u32 m0, s17, 98304
  s_lshl4_add_u32 s95, s25, s21
  v_mfma_f32_32x32x16_bf16 v[72:87], v[196:199], a[12:15], v[72:87]
  buffer_load_dwordx4 v28, s[44:47], s95 offen lds
  v_bfe_u32 v8, v52, 3, 1
  v_and_b32_e64 v9, 7, v52
  v_lshl_add_u32 v8, v8, 4, v9
  v_bfe_u32 v9, v52, 4, 1
  v_lshl_add_u32 v8, v9, 3, v8
  v_and_b32 v10, 32, v52
  v_lshl_add_u32 v8, v8, 6, v10
  s_waitcnt lgkmcnt(2)
  v_mfma_f32_32x32x16_bf16 v[72:87], v[200:203], a[16:19], v[72:87]
  v_lshl_add_u32 v20, s89, 1, v8
  v_lshrrev_b32_e64 v8, 5, v52
  v_bfe_u32 v10, v52, 2, 2
  v_lshl_add_u32 v8, v8, 3, v10
  v_lshl_add_u32 v8, v8, 1, v9
  v_and_b32_e64 v10, 3, v52
  v_lshl_add_u32 v8, v8, 2, v10
  v_lshlrev_b32 v8, 3, v8
  v_lshl_add_u32 v21, s89, 1, v8
  v_mfma_f32_16x16x32_bf16 a[32:35], a[36:39], a[16:19], a[32:35]
  v_mfma_f32_32x32x16_bf16 v[72:87], v[204:207], a[20:23], v[72:87]
  v_and_or_b32 v23, v38, -9, s99
  s_nop 5
  ds_write_b32 v23, a32 offset:0
  s_waitcnt vmcnt(8) lgkmcnt(0)
  s_barrier
  ds_read_b64 v[22:23], v38 offset:0
  ds_read_b64_tr_b16 a[0:1], v33 offset:49152
  ds_read_b64_tr_b16 a[2:3], v33 offset:49664
  ds_read_b64_tr_b16 a[4:5], v34 offset:49152
  ds_read_b64_tr_b16 a[6:7], v34 offset:49664
  ds_read_b64_tr_b16 a[8:9], v35 offset:49152
  ds_read_b64_tr_b16 a[10:11], v35 offset:49664
  ds_read_b64_tr_b16 a[12:13], v36 offset:49152
  ds_read_b64_tr_b16 a[14:15], v36 offset:49664
  ds_read_b64_tr_b16 a[16:17], v33 offset:40960
  ds_read_b64_tr_b16 a[18:19], v33 offset:41472
  ds_read_b64_tr_b16 a[20:21], v34 offset:40960
  ds_read_b64_tr_b16 a[22:23], v34 offset:41472
  s_add_u32 m0, s89, 65408
  v_mfma_f32_32x32x16_bf16 v[72:87], v[208:211], a[24:27], v[72:87]
  buffer_load_dwordx4 v26, s[36:39], s79 offen offset:128 lds
  v_lshrrev_b32 v2, 5, v52
  v_lshlrev_b32 v3, 6, v2
  v_lshl_add_u32 v3, s80, 7, v3
  ds_read_b128 v[4:7], v3 offset:1024
  ds_read_b64_tr_b16 a[24:25], v35 offset:40960
  ds_read_b64_tr_b16 a[26:27], v35 offset:41472
  v_mfma_f32_32x32x16_bf16 v[72:87], v[212:215], a[28:31], v[72:87]
  ds_read_b128 v[8:11], v3 offset:1040
  ds_read_b128 v[12:15], v3 offset:1056
  ds_read_b128 v[16:19], v3 offset:1072
  v_and_b32_e64 v0, 31, v52
  ds_read_b64_tr_b16 a[28:29], v36 offset:40960
  ds_read_b64_tr_b16 a[30:31], v36 offset:41472
  s_waitcnt lgkmcnt(15)
  s_add_u32 m0, s18, 98304
  s_lshl4_add_u32 s95, s25, s22
  v_mfma_f32_32x32x16_bf16 v[56:71], a[0:3], v[88:91], 0
  buffer_load_dwordx4 v28, s[44:47], s95 offen lds
  v_lshlrev_b32_e64 v0, 2, v0
  v_lshl_add_u32 v53, s82, 10, v0
  v_lshl_add_u32 v54, v2, 7, v53
  v_lshl_add_u32 v54, s81, 8, v54
  v_mfma_f32_16x16x32_bf16 a[32:35], a[36:39], a[0:3], 0
  ds_read_b64_tr_b16 a[0:1], v33 offset:32768
  ds_read_b64_tr_b16 a[2:3], v33 offset:33280
  v_mfma_f32_32x32x16_bf16 v[56:71], a[4:7], v[92:95], v[56:71]
  s_lshl2_add_u32 s30, s87, s81
  s_mul_i32 s30, s30, 88
  s_add_u32 s30, s30, s82
  s_add_u32 s30, s30, 512
  v_lshl_add_u32 v26, s30, 10, v55
  v_add_f32 v22, v22, v23
  s_nop 1
  v_mfma_f32_32x32x2_f32 v[72:87], v50, v22, v[72:87]
  ds_read_b64_tr_b16 a[4:5], v34 offset:32768
  ds_read_b64_tr_b16 a[6:7], v34 offset:33280
  s_waitcnt lgkmcnt(15)
  v_mfma_f32_32x32x16_bf16 v[56:71], a[8:11], v[96:99], v[56:71]
  s_mov_b64 s[36:37], s[56:57]
  s_cmp_eq_u32 s85, 3
  s_cselect_b32 s38, 0, s58
  s_add_u32 s90, s90, 32768
  v_and_b32 v0, 3, v52
  ds_read_b64_tr_b16 a[8:9], v35 offset:32768
  ds_read_b64_tr_b16 a[10:11], v35 offset:33280
  s_add_u32 m0, s19, 98304
  s_lshl4_add_u32 s95, s25, s23
  v_mfma_f32_32x32x16_bf16 v[56:71], a[12:15], v[100:103], v[56:71]
  buffer_load_dwordx4 v28, s[44:47], s95 offen lds
  v_bfe_u32 v1, v52, 4, 1
  v_lshl_add_u32 v0, v1, 2, v0
  v_bfe_u32 v1, v52, 3, 1
  v_lshl_add_u32 v0, v1, 3, v0
  ds_read_b64_tr_b16 a[12:13], v36 offset:32768
  ds_read_b64_tr_b16 a[14:15], v36 offset:33280
  s_waitcnt lgkmcnt(15)
  v_mfma_f32_32x32x16_bf16 v[56:71], a[16:19], v[104:107], v[56:71]
  s_waitcnt lgkmcnt(15)
  v_mul_f32 v72, v4, v72
  v_mul_f32 v73, v5, v73
  v_fmac_f32_e64 v73, v39, v72
  v_bfe_u32 v1, v52, 2, 2
  v_lshl_add_u32 v0, v1, 4, v0
  v_mul_f32_e64 v74, v6, v74
  v_fmac_f32_dpp v73, v72, v40 row_ror:8 row_mask:0xf bank_mask:0xf
  v_fmac_f32_e64 v74, v39, v73
  v_mfma_f32_16x16x32_bf16 a[32:35], a[36:39], a[16:19], a[32:35]
  ds_read_b64_tr_b16 a[16:17], v33 offset:24576
  ds_read_b64_tr_b16 a[18:19], v33 offset:25088
  s_waitcnt vmcnt(4)
  s_barrier
  s_cmp_lg_u32 s80, 0
  s_cbranch_scc1 Lfl_7
  v_mov_b32 v22, s96
  v_mov_b32 v23, s97
  s_mov_b64 exec, 1
  buffer_store_dwordx2 v[22:23], off, s[56:59], s92 offset:0 sc1
  s_mov_b64 exec, -1
Lfl_7:
  v_mfma_f32_32x32x16_bf16 v[56:71], a[20:23], v[108:111], v[56:71]
  v_lshrrev_b32_e64 v2, 5, v52
  v_lshl_add_u32 v0, v2, 6, v0
  v_mul_f32_e64 v75, v7, v75
  v_fmac_f32_dpp v74, v73, v40 row_ror:8 row_mask:0xf bank_mask:0xf
  v_fmac_f32 v75, v39, v74
  s_lshl_b32 s30, s81, 13
  s_add_u32 s30, s30, 98304
  v_lshl_add_u32 v29, v0, 3, s30
  ds_read_b64_tr_b16 a[20:21], v34 offset:24576
  ds_read_b64_tr_b16 a[22:23], v34 offset:25088
  s_waitcnt lgkmcnt(12)
  s_add_u32 m0, s89, 73728
  s_lshl4_add_u32 s95, s26, 458752
  v_mfma_f32_32x32x16_bf16 v[56:71], a[24:27], v[112:115], v[56:71]
  buffer_load_dwordx4 v28, s[44:47], s95 offen lds
  v_mul_f32 v76, v8, v76
  v_fmac_f32_dpp v75, v74, v40 row_ror:8 row_mask:0xf bank_mask:0xf
  v_fmac_f32_e64 v76, v39, v75
  v_mul_f32 v77, v9, v77
  s_nop 0
  v_fmac_f32_dpp v76, v75, v40 row_ror:8 row_mask:0xf bank_mask:0xf
  v_fmac_f32_e64 v77, v39, v76
  ds_read_b64_tr_b16 a[24:25], v35 offset:24576
  ds_read_b64_tr_b16 a[26:27], v35 offset:25088
  v_mfma_f32_32x32x16_bf16 v[56:71], a[28:31], v[116:119], v[56:71]
  v_xor_b32 v30, 64, v29
  v_lshrrev_b32 v0, 5, v52
  v_mul_f32_e64 v78, v10, v78
  v_fmac_f32_dpp v77, v76, v40 row_ror:8 row_mask:0xf bank_mask:0xf
  v_fmac_f32_e64 v78, v39, v77
  v_lshl_add_u32 v0, s81, 1, v0
  v_mul_f32 v79, v11, v79
  ds_read_b64_tr_b16 a[28:29], v36 offset:24576
  ds_read_b64_tr_b16 a[30:31], v36 offset:25088
  s_waitcnt lgkmcnt(12)
  v_mfma_f32_32x32x16_bf16 v[56:71], a[0:3], v[120:123], v[56:71]
  v_fmac_f32_dpp v78, v77, v40 row_ror:8 row_mask:0xf bank_mask:0xf
  v_fmac_f32_e64 v79, v39, v78
  v_bfe_u32 v1, v52, 3, 1
  v_lshl_add_u32 v0, v0, 1, v1
  v_mul_f32_e64 v80, v12, v80
  v_fmac_f32_dpp v79, v78, v40 row_ror:8 row_mask:0xf bank_mask:0xf
  v_fmac_f32_e64 v80, v39, v79
  v_mfma_f32_16x16x32_bf16 a[32:35], a[36:39], a[0:3], a[32:35]
  ds_read_b64_tr_b16 a[0:1], v33 offset:16384
  ds_read_b64_tr_b16 a[2:3], v33 offset:16896
  s_add_u32 m0, s89, 81920
  s_lshl4_add_u32 s95, s26, 917504
  v_mfma_f32_32x32x16_bf16 v[56:71], a[4:7], v[124:127], v[56:71]
  buffer_load_dwordx4 v28, s[44:47], s95 offen lds
  v_and_b32 v1, 0x17, v52
  s_lshl4_add_u32 s30, s83, s86
  s_lshl1_add_u32 s30, s30, s82
  s_lshl_b32 s30, s30, 9
  s_add_u32 s30, s30, 49152
  v_lshl_add_u32 v1, v1, 4, s30
  v_mul_f32_e64 v81, v13, v81
  v_fmac_f32_dpp v80, v79, v40 row_ror:8 row_mask:0xf bank_mask:0xf
  ds_read_b64_tr_b16 a[4:5], v34 offset:16384
  ds_read_b64_tr_b16 a[6:7], v34 offset:16896
  s_waitcnt lgkmcnt(12)
  v_mfma_f32_32x32x16_bf16 v[56:71], a[8:11], v[128:131], v[56:71]
  v_fmac_f32 v81, v39, v80
  v_mul_f32 v82, v14, v82
  s_nop 0
  v_fmac_f32_dpp v81, v80, v40 row_ror:8 row_mask:0xf bank_mask:0xf
  v_fmac_f32_e64 v82, v39, v81
  v_mul_f32 v83, v15, v83
  s_nop 0
  v_fmac_f32_dpp v82, v81, v40 row_ror:8 row_mask:0xf bank_mask:0xf
  v_fmac_f32_e64 v83, v39, v82
  ds_read_b64_tr_b16 a[8:9], v35 offset:16384
  ds_read_b64_tr_b16 a[10:11], v35 offset:16896
  v_mfma_f32_32x32x16_bf16 v[56:71], a[12:15], v[132:135], v[56:71]
  v_lshlrev_b32 v2, 14, v0
  v_mul_f32 v84, v16, v84
  v_fmac_f32_dpp v83, v82, v40 row_ror:8 row_mask:0xf bank_mask:0xf
  v_fmac_f32_e64 v84, v39, v83
  v_cmp_le_u32 s[12:13], s83, v0
  v_mul_f32 v85, v17, v85
  v_fmac_f32_dpp v84, v83, v40 row_ror:8 row_mask:0xf bank_mask:0xf
  ds_read_b64_tr_b16 a[12:13], v36 offset:16384
  ds_read_b64_tr_b16 a[14:15], v36 offset:16896
  s_waitcnt lgkmcnt(12)
  s_add_u32 m0, s89, 90112
  s_lshl4_add_u32 s95, s26, 1376256
  v_mfma_f32_32x32x16_bf16 v[56:71], a[16:19], v[136:139], v[56:71]
  buffer_load_dwordx4 v28, s[44:47], s95 offen lds
  v_fmac_f32 v85, v39, v84
  v_sub_u32 v1, v1, v2
  v_mov_b32 v3, 1073741824
  v_mul_f32 v86, v18, v86
  v_fmac_f32_dpp v85, v84, v40 row_ror:8 row_mask:0xf bank_mask:0xf
  v_fmac_f32_e64 v86, v39, v85
  s_mov_b32 s14, 0xff00ff00
  v_mfma_f32_16x16x32_bf16 a[32:35], a[36:39], a[16:19], a[32:35]
  ds_read_b64_tr_b16 a[16:17], v33 offset:8192
  ds_read_b64_tr_b16 a[18:19], v33 offset:8704
  v_mfma_f32_32x32x16_bf16 v[56:71], a[20:23], v[140:143], v[56:71]
  s_mov_b32 s15, 0xff00ff00
  v_mul_f32_e64 v87, v19, v87
  v_fmac_f32_dpp v86, v85, v40 row_ror:8 row_mask:0xf bank_mask:0xf
  v_fmac_f32 v87, v39, v86
  v_cndmask_b32 v31, v1, v3, s[12:13]
  s_nop 0
  v_fmac_f32_dpp v87, v86, v40 row_ror:8 row_mask:0xf bank_mask:0xf
  ds_write_b32 v54, v87 offset:4096
  s_waitcnt vmcnt(5) lgkmcnt(0)
  s_barrier
  ds_read_b64_tr_b16 a[20:21], v34 offset:8192
  ds_read_b64_tr_b16 a[22:23], v34 offset:8704
  v_mfma_f32_32x32x16_bf16 v[56:71], a[24:27], v[144:147], v[56:71]
  v_add_u32 v9, 4096, v53
  ds_read2_b32 v[0:1], v9 offset0:0 offset1:32
  ds_read2_b32 v[2:3], v9 offset0:64 offset1:96
  ds_read2_b32 v[4:5], v9 offset0:128 offset1:160
  ds_read2_b32 v[6:7], v9 offset0:192 offset1:224
  v_lshrrev_b32_e64 v8, 5, v52
  v_lshl_add_u32 v8, s81, 1, v8
  ds_read_b64_tr_b16 a[24:25], v35 offset:8192
  ds_read_b64_tr_b16 a[26:27], v35 offset:8704
  s_add_u32 m0, s16, 32768
  s_lshl4_add_u32 s95, s27, s20
  v_mfma_f32_32x32x16_bf16 v[56:71], a[28:31], v[148:151], v[56:71]
  buffer_load_dwordx4 v28, s[44:47], s95 offen lds
  buffer_load_dword v32, v24, s[56:59], 0 offen offset:0 sc1
  v_mov_b32 v53, 0
  v_mov_b32 v10, s96
  v_mov_b32 v11, s97
  ds_read_b64_tr_b16 a[28:29], v36 offset:8192
  ds_read_b64_tr_b16 a[30:31], v36 offset:8704
  v_mfma_f32_32x32x16_bf16 v[56:71], a[0:3], v[152:155], v[56:71]
  v_cmp_eq_u32 vcc, 1, v8
  s_waitcnt lgkmcnt(7)
  v_fmac_f32_dpp v1, v0, v44 row_ror:8 row_mask:0xf bank_mask:0xf
  v_fmac_f32_e64 v1, v43, v0
  v_mfma_f32_16x16x32_bf16 a[32:35], a[36:39], a[0:3], a[32:35]
  ds_read_b64_tr_b16 a[0:1], v33 offset:0
  ds_read_b64_tr_b16 a[2:3], v33 offset:512
  s_add_u32 m0, s17, 32768
  s_lshl4_add_u32 s95, s27, s21
  v_mfma_f32_32x32x16_bf16 v[56:71], a[4:7], v[156:159], v[56:71]
  buffer_load_dwordx4 v28, s[44:47], s95 offen lds
  v_cndmask_b32 v53, v53, v0, vcc
  v_cmp_eq_u32 vcc, 2, v8
  s_waitcnt lgkmcnt(8)
  v_fmac_f32_dpp v2, v1, v44 row_ror:8 row_mask:0xf bank_mask:0xf
  v_fmac_f32 v2, v43, v1
  v_cndmask_b32 v53, v53, v1, vcc
  v_cmp_eq_u32_e64 vcc, 3, v8
  v_fmac_f32_dpp v3, v2, v44 row_ror:8 row_mask:0xf bank_mask:0xf
  ds_read_b64_tr_b16 a[4:5], v34 offset:0
  ds_read_b64_tr_b16 a[6:7], v34 offset:512
  v_mfma_f32_32x32x16_bf16 v[56:71], a[8:11], v[160:163], v[56:71]
  v_fmac_f32 v3, v43, v2
  v_cndmask_b32 v53, v53, v2, vcc
  v_cmp_eq_u32 vcc, 4, v8
  s_waitcnt lgkmcnt(9)
  v_fmac_f32_dpp v4, v3, v44 row_ror:8 row_mask:0xf bank_mask:0xf
  v_fmac_f32 v4, v43, v3
  v_cndmask_b32 v53, v53, v3, vcc
  v_cmp_eq_u32 vcc, 5, v8
  ds_read_b64_tr_b16 a[8:9], v35 offset:0
  ds_read_b64_tr_b16 a[10:11], v35 offset:512
  s_add_u32 m0, s18, 32768
  s_lshl4_add_u32 s95, s27, s22
  v_mfma_f32_32x32x16_bf16 v[56:71], a[12:15], v[164:167], v[56:71]
  buffer_load_dwordx4 v28, s[44:47], s95 offen lds
  v_fmac_f32_dpp v5, v4, v44 row_ror:8 row_mask:0xf bank_mask:0xf
  v_fmac_f32 v5, v43, v4
  v_cndmask_b32 v53, v53, v4, vcc
  v_cmp_eq_u32 vcc, 6, v8
  s_waitcnt lgkmcnt(10)
  v_fmac_f32_dpp v6, v5, v44 row_ror:8 row_mask:0xf bank_mask:0xf
  v_fmac_f32 v6, v43, v5
  v_cndmask_b32 v53, v53, v5, vcc
  ds_read_b64_tr_b16 a[12:13], v36 offset:0
  ds_read_b64_tr_b16 a[14:15], v36 offset:512
  v_mfma_f32_32x32x16_bf16 v[56:71], a[16:19], v[168:171], v[56:71]
  v_cmp_eq_u32_e64 vcc, 7, v8
  v_fmac_f32_dpp v7, v6, v44 row_ror:8 row_mask:0xf bank_mask:0xf
  v_fmac_f32 v7, v43, v6
  v_cndmask_b32 v53, v53, v6, vcc
  v_mov_b32 v8, v7
  s_cmp_lg_u32 s81, 0
  s_cbranch_scc1 Lep_8
  s_lshl4_add_u32 s30, s83, s86
  s_lshl1_add_u32 s30, s30, s82
  v_mov_b32_dpp v9, v7 row_ror:8 row_mask:0xf bank_mask:0xf
  s_lshl_b32 s30, s30, 9
  s_add_u32 s30, s30, 65536
  s_mov_b64 exec, 0x00ff00ff
  buffer_store_dwordx4 v[8:11], v55, s[56:59], s30 offen sc1
  s_mov_b64 exec, -1
Lep_8:
  v_mfma_f32_16x16x32_bf16 a[32:35], a[36:39], a[16:19], a[32:35]
  ds_read_b64_tr_b16 a[16:17], v33 offset:57344
  ds_read_b64_tr_b16 a[18:19], v33 offset:57856
  s_add_u32 m0, s19, 32768
  s_lshl4_add_u32 s95, s27, s23
  v_mfma_f32_32x32x16_bf16 v[56:71], a[20:23], v[172:175], v[56:71]
  buffer_load_dwordx4 v28, s[44:47], s95 offen lds
  ds_read_b64_tr_b16 a[20:21], v34 offset:57344
  ds_read_b64_tr_b16 a[22:23], v34 offset:57856
  s_waitcnt lgkmcnt(12)
  v_mfma_f32_32x32x16_bf16 v[56:71], a[24:27], v[176:179], v[56:71]
  s_mov_b32 s93, 0x4000
  s_waitcnt vmcnt(3)
Lpl_9:
  v_cmp_eq_u32 s[100:101], v25, v32
  s_nop 0
  s_cmp_eq_u64 s[100:101], -1
  s_cbranch_scc1 Lpd_10
  s_sub_u32 s93, s93, 1
  s_cbranch_scc1 Lpd_10
  buffer_load_dword v32, v24, s[56:59], 0 offen offset:0 sc1
  s_waitcnt vmcnt(0)
  s_branch Lpl_9
Lpd_10:
  v_mul_f32 v12, v48, v48
  v_mul_f32_e64 v44, v47, v48
  v_fma_f32 v43, v47, v47, -v12
  v_add_f32_e64 v44, v44, v44
  ds_read_b64_tr_b16 a[24:25], v35 offset:57344
  ds_read_b64_tr_b16 a[26:27], v35 offset:57856
  v_mfma_f32_32x32x16_bf16 v[56:71], a[28:31], v[180:183], v[56:71]
  s_add_u32 s94, s24, 0
  buffer_load_dwordx4 v[88:91], v26, s[56:59], s94 offen offset:0 sc1
  v_mul_f32_dpp v12, v72, v42 row_ror:8 row_mask:0xf bank_mask:0xf
  v_mul_f32_dpp v13, v73, v42 row_ror:8 row_mask:0xf bank_mask:0xf
  v_fma_f32 v72, v41, v72, v12
  v_fma_f32 v73, v41, v73, v13
  v_mul_f32_dpp v12, v74, v42 row_ror:8 row_mask:0xf bank_mask:0xf
  ds_read_b64_tr_b16 a[28:29], v36 offset:57344
  ds_read_b64_tr_b16 a[30:31], v36 offset:57856
  s_waitcnt lgkmcnt(12)
  v_mfma_f32_32x32x16_bf16 v[56:71], a[0:3], v[184:187], v[56:71]
  buffer_load_dwordx4 v[92:95], v26, s[56:59], s94 offen offset:2048 sc1
  s_add_u32 s94, s24, 4096
  buffer_load_dwordx4 v[96:99], v26, s[56:59], s94 offen offset:0 sc1
  v_mul_f32_dpp v13, v75, v42 row_ror:8 row_mask:0xf bank_mask:0xf
  v_fma_f32 v74, v41, v74, v12
  v_fma_f32 v75, v41, v75, v13
  v_mul_f32_dpp v12, v76, v42 row_ror:8 row_mask:0xf bank_mask:0xf
  v_mul_f32_dpp v13, v77, v42 row_ror:8 row_mask:0xf bank_mask:0xf
  v_mfma_f32_16x16x32_bf16 a[32:35], a[36:39], a[0:3], a[32:35]
  v_mfma_f32_32x32x16_bf16 v[56:71], a[4:7], v[188:191], v[56:71]
  v_fma_f32 v76, v41, v76, v12
  v_fma_f32 v77, v41, v77, v13
  v_mul_f32_dpp v12, v78, v42 row_ror:8 row_mask:0xf bank_mask:0xf
  v_mul_f32_dpp v13, v79, v42 row_ror:8 row_mask:0xf bank_mask:0xf
  s_waitcnt lgkmcnt(8)
  v_mfma_f32_32x32x16_bf16 v[56:71], a[8:11], v[192:195], v[56:71]
  buffer_load_dwordx4 v[100:103], v26, s[56:59], s94 offen offset:2048 sc1
  s_add_u32 s94, s25, 0
  buffer_load_dwordx4 v[104:107], v26, s[56:59], s94 offen offset:0 sc1
  v_fma_f32 v78, v41, v78, v12
  v_fma_f32 v79, v41, v79, v13
  v_mul_f32_dpp v12, v80, v42 row_ror:8 row_mask:0xf bank_mask:0xf
  v_mul_f32_dpp v13, v81, v42 row_ror:8 row_mask:0xf bank_mask:0xf
  v_fma_f32 v80, v41, v80, v12
  v_mfma_f32_32x32x16_bf16 v[56:71], a[12:15], v[196:199], v[56:71]
  v_fma_f32 v81, v41, v81, v13
  v_mul_f32_dpp v12, v82, v42 row_ror:8 row_mask:0xf bank_mask:0xf
  v_mul_f32_dpp v13, v83, v42 row_ror:8 row_mask:0xf bank_mask:0xf
  v_fma_f32 v82, v41, v82, v12
  s_waitcnt lgkmcnt(4)
  v_mfma_f32_32x32x16_bf16 v[56:71], a[16:19], v[200:203], v[56:71]
  buffer_load_dwordx4 v[108:111], v26, s[56:59], s94 offen offset:2048 sc1
  s_add_u32 s94, s25, 4096
  buffer_load_dwordx4 v[112:115], v26, s[56:59], s94 offen offset:0 sc1
  v_fma_f32 v83, v41, v83, v13
  v_mul_f32_dpp v12, v84, v42 row_ror:8 row_mask:0xf bank_mask:0xf
  v_mul_f32_dpp v13, v85, v42 row_ror:8 row_mask:0xf bank_mask:0xf
  v_fma_f32 v84, v41, v84, v12
  v_fma_f32 v85, v41, v85, v13
  v_mfma_f32_16x16x32_bf16 a[32:35], a[36:39], a[16:19], a[32:35]
  v_mfma_f32_32x32x16_bf16 v[56:71], a[20:23], v[204:207], v[56:71]
  v_and_or_b32 v23, v38, -9, s99
  s_nop 5
  ds_write_b32 v23, a32 offset:0
  v_mul_f32_dpp v12, v86, v42 row_ror:8 row_mask:0xf bank_mask:0xf
  v_mul_f32_dpp v13, v87, v42 row_ror:8 row_mask:0xf bank_mask:0xf
  v_fma_f32 v86, v41, v86, v12
  v_fma_f32 v87, v41, v87, v13
  s_waitcnt lgkmcnt(0)
  s_barrier
  ds_read_b64 v[22:23], v38 offset:0
  s_add_u32 m0, s89, 65536
  s_lshl4_add_u32 s95, s26, 0
  v_mfma_f32_32x32x16_bf16 v[56:71], a[24:27], v[208:211], v[56:71]
  buffer_load_dwordx4 v28, s[44:47], s95 offen lds
  v_mfma_f32_32x32x16_bf16 v[56:71], a[28:31], v[212:215], v[56:71]
  s_waitcnt lgkmcnt(0)
  v_add_f32 v22, v22, v23
  s_nop 7
  v_mfma_f32_32x32x2_f32 v[56:71], v22, v50, v[56:71]
  s_mov_b32 s19, 0
  s_lshr_b32 s19, 0x24924, s19
  s_bfe_u32 s16, s19, 131072
  s_lshl1_add_u32 s16, s16, 1
  s_lshl_b32 s16, s16, 12
  s_bfe_u32 s17, s19, 131074
  s_lshl1_add_u32 s17, s17, 1
  s_lshl_b32 s17, s17, 12
  s_bfe_u32 s18, s19, 131076
  s_lshl1_add_u32 s18, s18, 1
  s_lshl_b32 s18, s18, 12
  s_and_b32 s21, s88, 0
  s_lshl_b32 s21, s21, 7
  s_xor_b32 s22, s21, 128
  s_lshl_b32 s19, s21, 7
  s_lshl_b32 s20, s22, 7
  buffer_load_dwordx4 v[16:19], v31, s[56:59], 0 offen sc1
  buffer_load_dwordx4 v[116:119], v26, s[56:59], s94 offen offset:2048 sc1
  s_add_u32 s94, s26, 0
  buffer_load_dwordx4 v[120:123], v26, s[56:59], s94 offen offset:0 sc1
  ds_read_b64_tr_b16 a[0:1], v29 offset:32768
  ds_read_b64_tr_b16 a[2:3], v29 offset:33792
  ds_read_b64_tr_b16 a[4:5], v30 offset:32768
  ds_read_b64_tr_b16 a[6:7], v30 offset:33792
  ds_read_b64_tr_b16 a[8:9], v29 offset:34816
  ds_read_b64_tr_b16 a[10:11], v29 offset:35840
  ds_read_b64_tr_b16 a[12:13], v30 offset:34816
  ds_read_b64_tr_b16 a[14:15], v30 offset:35840
  ds_read_b64_tr_b16 a[16:17], v29 offset:36864
  ds_read_b64_tr_b16 a[18:19], v29 offset:37888
  ds_read_b64_tr_b16 a[20:21], v30 offset:36864
  ds_read_b64_tr_b16 a[22:23], v30 offset:37888
  ds_read_b64_tr_b16 a[24:25], v29 offset:38912
  ds_read_b64_tr_b16 a[26:27], v29 offset:39936
  ds_read_b64_tr_b16 a[28:29], v30 offset:38912
  ds_read_b64_tr_b16 a[30:31], v30 offset:39936
  s_waitcnt vmcnt(10) lgkmcnt(12)
  v_mfma_f32_32x32x16_bf16 v[184:199], v[88:91], a[0:3], 0
  buffer_load_dwordx4 v[124:127], v26, s[56:59], s94 offen offset:2048 sc1
  v_mfma_f32_32x32x16_bf16 v[200:215], v[88:91], a[4:7], 0
  s_add_u32 s94, s26, 4096
  buffer_load_dwordx4 v[128:131], v26, s[56:59], s94 offen offset:0 sc1
  v_mul_f32 v8, v49, v56
  v_mul_f32 v9, v49, v57
  v_mul_f32 v10, v49, v58
  v_mul_f32 v11, v49, v59
  v_exp_f32 v8, v8
  v_exp_f32 v9, v9
  v_exp_f32 v10, v10
  v_exp_f32 v11, v11
  ds_read_b64_tr_b16 a[0:1], v29 offset:0
  ds_read_b64_tr_b16 a[2:3], v29 offset:1024
  ds_read_b64_tr_b16 a[4:5], v30 offset:0
  ds_read_b64_tr_b16 a[6:7], v30 offset:1024
  s_waitcnt vmcnt(11) lgkmcnt(12)
  v_mfma_f32_32x32x16_bf16 v[184:199], v[92:95], a[8:11], v[184:199]
  v_fma_f32 v8, v8, v51, v51
  v_fma_f32 v9, v9, v51, v51
  v_fma_f32 v10, v10, v51, v51
  v_fma_f32 v11, v11, v51, v51
  v_rcp_f32 v8, v8
  v_rcp_f32 v9, v9
  v_rcp_f32_e64 v10, v10
  v_mfma_f32_32x32x16_bf16 v[200:215], v[92:95], a[12:15], v[200:215]
  buffer_load_dwordx4 v[132:135], v26, s[56:59], s94 offen offset:2048 sc1
  v_rcp_f32 v11, v11
  v_mul_f32 v56, v56, v8
  v_mul_f32 v57, v57, v9
  v_mul_f32 v58, v58, v10
  v_mul_f32_e64 v59, v59, v11
  v_cvt_pk_bf16_f32 v56, v56, v57
  v_cvt_pk_bf16_f32 v57, v58, v59
  v_mul_f32_e64 v12, v49, v60
  ds_read_b64_tr_b16 a[8:9], v29 offset:2048
  ds_read_b64_tr_b16 a[10:11], v29 offset:3072
  ds_read_b64_tr_b16 a[12:13], v30 offset:2048
  ds_read_b64_tr_b16 a[14:15], v30 offset:3072
  s_waitcnt vmcnt(11) lgkmcnt(12)
  v_mfma_f32_32x32x16_bf16 v[184:199], v[96:99], a[16:19], v[184:199]
  s_add_u32 s94, s27, 0
  buffer_load_dwordx4 v[136:139], v26, s[56:59], s94 offen offset:0 sc1
  v_mul_f32 v13, v49, v61
  v_mul_f32 v14, v49, v62
  v_mul_f32 v15, v49, v63
  v_exp_f32 v12, v12
  v_exp_f32 v13, v13
  v_exp_f32 v14, v14
  v_exp_f32_e64 v15, v15
  v_mfma_f32_32x32x16_bf16 v[200:215], v[96:99], a[20:23], v[200:215]
  v_fma_f32 v12, v12, v51, v51
  v_fma_f32 v13, v13, v51, v51
  v_fma_f32 v14, v14, v51, v51
  v_fma_f32 v15, v15, v51, v51
  v_rcp_f32 v12, v12
  v_rcp_f32 v13, v13
  v_rcp_f32 v14, v14
  v_rcp_f32 v15, v15
  ds_read_b64_tr_b16 a[16:17], v29 offset:4096
  ds_read_b64_tr_b16 a[18:19], v29 offset:5120
  ds_read_b64_tr_b16 a[20:21], v30 offset:4096
  ds_read_b64_tr_b16 a[22:23], v30 offset:5120
  s_waitcnt vmcnt(11) lgkmcnt(12)
  v_mfma_f32_32x32x16_bf16 v[184:199], v[100:103], a[24:27], v[184:199]
  buffer_load_dwordx4 v[140:143], v26, s[56:59], s94 offen offset:2048 sc1
  v_mul_f32 v60, v60, v12
  v_mul_f32 v61, v61, v13
  v_mul_f32 v62, v62, v14
  v_mul_f32_e64 v63, v63, v15
  v_cvt_pk_bf16_f32 v58, v60, v61
  v_cvt_pk_bf16_f32 v59, v62, v63
  buffer_store_dwordx4 v[56:59], v37, s[36:39], s90 offen offset:0 sc1
  v_mfma_f32_32x32x16_bf16 v[200:215], v[100:103], a[28:31], v[200:215]
  s_add_u32 s94, s27, 4096
  buffer_load_dwordx4 v[144:147], v26, s[56:59], s94 offen offset:0 sc1
  v_mul_f32 v8, v49, v64
  v_mul_f32 v9, v49, v65
  v_mul_f32 v10, v49, v66
  v_mul_f32 v11, v49, v67
  v_exp_f32 v8, v8
  v_exp_f32 v9, v9
  v_exp_f32_e64 v10, v10
  v_exp_f32 v11, v11
  ds_read_b64_tr_b16 a[24:25], v29 offset:6144
  ds_read_b64_tr_b16 a[26:27], v29 offset:7168
  ds_read_b64_tr_b16 a[28:29], v30 offset:6144
  ds_read_b64_tr_b16 a[30:31], v30 offset:7168
  s_waitcnt vmcnt(13) lgkmcnt(12)
  v_mfma_f32_32x32x16_bf16 v[184:199], v[104:107], a[0:3], v[184:199]
  v_fma_f32 v8, v8, v51, v51
  v_fma_f32 v9, v9, v51, v51
  v_fma_f32 v10, v10, v51, v51
  v_fma_f32 v11, v11, v51, v51
  v_rcp_f32 v8, v8
  v_rcp_f32 v9, v9
  v_rcp_f32_e64 v10, v10
  v_mfma_f32_32x32x16_bf16 v[200:215], v[104:107], a[4:7], v[200:215]
  buffer_load_dwordx4 v[148:151], v26, s[56:59], s94 offen offset:2048 sc1
  v_rcp_f32 v11, v11
  v_mul_f32 v64, v64, v8
  v_mul_f32 v65, v65, v9
  v_mul_f32 v66, v66, v10
  v_mul_f32_e64 v67, v67, v11
  v_cvt_pk_bf16_f32 v64, v64, v65
  v_cvt_pk_bf16_f32 v65, v66, v67
  v_mul_f32 v12, v49, v68
  s_waitcnt vmcnt(13) lgkmcnt(8)
  v_mfma_f32_32x32x16_bf16 v[184:199], v[108:111], a[8:11], v[184:199]
  v_mul_f32 v13, v49, v69
  v_mul_f32 v14, v49, v70
  v_mul_f32 v15, v49, v71
  v_exp_f32 v12, v12
  v_exp_f32 v13, v13
  v_exp_f32 v14, v14
  v_exp_f32_e64 v15, v15
  v_mfma_f32_32x32x16_bf16 v[200:215], v[108:111], a[12:15], v[200:215]
  v_fma_f32 v12, v12, v51, v51
  v_fma_f32 v13, v13, v51, v51
  v_fma_f32 v14, v14, v51, v51
  v_fma_f32 v15, v15, v51, v51
  v_rcp_f32 v12, v12
  v_rcp_f32 v13, v13
  v_rcp_f32_e64 v14, v14
  v_rcp_f32 v15, v15
  s_waitcnt vmcnt(12) lgkmcnt(4)
  v_mfma_f32_32x32x16_bf16 v[184:199], v[112:115], a[16:19], v[184:199]
  v_mul_f32 v68, v68, v12
  v_mul_f32 v69, v69, v13
  v_mul_f32 v70, v70, v14
  v_mul_f32 v71, v71, v15
  v_cvt_pk_bf16_f32 v66, v68, v69
  v_cvt_pk_bf16_f32 v67, v70, v71
  buffer_store_dwordx4 v[64:67], v37, s[36:39], s90 offen offset:2048 sc1
  v_mfma_f32_32x32x16_bf16 v[200:215], v[112:115], a[20:23], v[200:215]
  s_waitcnt vmcnt(10) lgkmcnt(0)
  v_mfma_f32_32x32x16_bf16 v[184:199], v[116:119], a[24:27], v[184:199]
  v_mfma_f32_32x32x16_bf16 v[200:215], v[116:119], a[28:31], v[200:215]
  s_mov_b32 s93, 0x4000
Lll_11:
  v_cmp_eq_u64 vcc, s[96:97], v[18:19]
  s_nop 0
  s_or_b64 vcc, vcc, s[12:13]
  s_cmp_eq_u64 vcc, -1
  s_cbranch_scc1 Lld_12
  s_sub_u32 s93, s93, 1
  s_cbranch_scc1 Lld_12
  buffer_load_dwordx4 v[16:19], v31, s[56:59], 0 offen sc1
  s_waitcnt vmcnt(0)
  s_branch Lll_11
Lld_12:
  v_mul_f32_e64 v0, v47, v16
  v_mul_f32 v1, v47, v17
  v_fma_f32 v0, -v48, v17, v0
  v_fma_f32 v1, v48, v16, v1
  v_cndmask_b32 v0, v17, v0, s[14:15]
  v_cndmask_b32 v1, v16, v1, s[14:15]
  v_and_b32 v22, 0x47c, v54
  s_nop 0
  v_add_f32_dpp v1, v0, v1 row_ror:8 row_mask:0xf bank_mask:0xf
  ds_write_b32 v54, v1 offset:6144
  s_waitcnt lgkmcnt(0)
  s_barrier
  v_add_u32 v22, 6144, v22
  ds_read2_b32 v[0:1], v22 offset0:0 offset1:32
  ds_read2_b32 v[2:3], v22 offset0:64 offset1:96
  ds_read2_b32 v[4:5], v22 offset0:128 offset1:160
  ds_read2_b32 v[6:7], v22 offset0:192 offset1:224
  v_add_u32 v29, 0xffff0000, v29
  v_add_u32 v30, 0xffff0000, v30
  ds_read_b64_tr_b16 a[0:1], v29 offset:32768
  ds_read_b64_tr_b16 a[2:3], v29 offset:33792
  ds_read_b64_tr_b16 a[4:5], v30 offset:32768
  ds_read_b64_tr_b16 a[6:7], v30 offset:33792
  ds_read_b64_tr_b16 a[8:9], v29 offset:34816
  ds_read_b64_tr_b16 a[10:11], v29 offset:35840
  ds_read_b64_tr_b16 a[12:13], v30 offset:34816
  ds_read_b64_tr_b16 a[14:15], v30 offset:35840
  ds_read_b64_tr_b16 a[16:17], v29 offset:36864
  ds_read_b64_tr_b16 a[18:19], v29 offset:37888
  ds_read_b64_tr_b16 a[20:21], v30 offset:36864
  ds_read_b64_tr_b16 a[22:23], v30 offset:37888
  ds_read_b64_tr_b16 a[24:25], v29 offset:38912
  ds_read_b64_tr_b16 a[26:27], v29 offset:39936
  ds_read_b64_tr_b16 a[28:29], v30 offset:38912
  ds_read_b64_tr_b16 a[30:31], v30 offset:39936
  s_waitcnt vmcnt(9) lgkmcnt(12)
  s_add_u32 m0, s89, 131072
  s_lshl4_add_u32 s95, s16, 0
  v_mfma_f32_32x32x16_bf16 v[184:199], v[120:123], a[0:3], v[184:199]
  buffer_load_dwordx4 v28, s[44:47], s95 offen lds
  s_add_u32 m0, s89, 139264
  s_lshl4_add_u32 s95, s16, 458752
  v_mfma_f32_32x32x16_bf16 v[200:215], v[120:123], a[4:7], v[200:215]
  buffer_load_dwordx4 v28, s[44:47], s95 offen lds
  v_fmac_f32 v6, v43, v7
  s_add_u32 s24, s88, 0
  s_add_u32 s25, s88, 1
  s_add_u32 s26, s88, 2
  v_fmac_f32_dpp v6, v7, v44 row_ror:8 row_mask:0xf bank_mask:0xf
  v_fmac_f32_e64 v5, v43, v6
  s_add_u32 s27, s88, 3
  ds_read_b64_tr_b16 a[0:1], v29 offset:0
  ds_read_b64_tr_b16 a[2:3], v29 offset:1024
  ds_read_b64_tr_b16 a[4:5], v30 offset:0
  ds_read_b64_tr_b16 a[6:7], v30 offset:1024
  s_waitcnt vmcnt(10) lgkmcnt(12)
  s_add_u32 m0, s89, 147456
  s_lshl4_add_u32 s95, s16, 917504
  v_mfma_f32_32x32x16_bf16 v[184:199], v[124:127], a[8:11], v[184:199]
  buffer_load_dwordx4 v28, s[44:47], s95 offen lds
  s_and_b32 s24, s24, 3
  s_lshl_b32 s40, s24, 13
  v_fmac_f32_dpp v5, v6, v44 row_ror:8 row_mask:0xf bank_mask:0xf
  v_fmac_f32_e64 v4, v43, v5
  s_lshl_b32 s24, s24, 8
  s_add_u32 s40, s40, s89
  v_fmac_f32_dpp v4, v5, v44 row_ror:8 row_mask:0xf bank_mask:0xf
  s_add_u32 m0, s89, 155648
  s_lshl4_add_u32 s95, s16, 1376256
  v_mfma_f32_32x32x16_bf16 v[200:215], v[124:127], a[12:15], v[200:215]
  buffer_load_dwordx4 v28, s[44:47], s95 offen lds
  v_fmac_f32 v3, v43, v4
  s_add_u32 s24, s24, s21
  s_and_b32 s25, s25, 3
  s_lshl_b32 s41, s25, 13
  v_fmac_f32_dpp v3, v4, v44 row_ror:8 row_mask:0xf bank_mask:0xf
  v_fmac_f32 v2, v43, v3
  s_lshl_b32 s25, s25, 8
  ds_read_b64_tr_b16 a[8:9], v29 offset:2048
  ds_read_b64_tr_b16 a[10:11], v29 offset:3072
  ds_read_b64_tr_b16 a[12:13], v30 offset:2048
  ds_read_b64_tr_b16 a[14:15], v30 offset:3072
  s_waitcnt vmcnt(4) lgkmcnt(0)
  s_barrier
  s_cmp_lg_u32 s80, 0
  s_cbranch_scc1 Lfl_14
  v_mov_b32 v18, s96
  v_mov_b32 v19, s97
  s_mov_b64 exec, 1
  buffer_store_dwordx2 v[18:19], off, s[56:59], s92 offset:512 sc1
  s_mov_b64 exec, -1
Lfl_14:
  v_mfma_f32_32x32x16_bf16 v[184:199], v[128:131], a[16:19], v[184:199]
  s_add_u32 s41, s41, s89
  s_add_u32 s25, s25, s21
  v_fmac_f32_dpp v2, v3, v44 row_ror:8 row_mask:0xf bank_mask:0xf
  v_fmac_f32 v1, v43, v2
  s_and_b32 s26, s26, 3
  s_lshl_b32 s42, s26, 13
  v_fmac_f32_dpp v1, v2, v44 row_ror:8 row_mask:0xf bank_mask:0xf
  s_add_u32 m0, s89, 98304
  s_lshl4_add_u32 s95, s17, 0
  v_mfma_f32_32x32x16_bf16 v[200:215], v[128:131], a[20:23], v[200:215]
  buffer_load_dwordx4 v28, s[44:47], s95 offen lds
  v_lshrrev_b32_e64 v16, 3, v52
  v_and_b32 v17, 0x70, v55
  v_lshl_add_u32 v16, v16, 10, v17
  s_lshl3_add_u32 s30, s87, s80
  s_lshl_b32 s30, s30, 6
  s_add_u32 s30, s30, s88
  s_lshl_b32 s30, s30, 7
  s_add_u32 m0, s89, 24576
  v_add_u32 v16, s30, v16
  buffer_load_dwordx4 v16, s[32:35], 0 offen lds
  s_cmp_lg_u32 s80, 0
  s_cbranch_scc1 Los_13
  s_lshl_b32 s30, s87, 9
  s_add_u32 s30, s30, 32768
  s_mov_b32 m0, 3072
  s_mov_b32 exec_hi, 0
  buffer_load_dwordx4 v55, s[56:59], s30 offen sc1 lds
  s_mov_b32 exec_hi, -1
Los_13:
  v_fmac_f32 v0, v43, v1
  s_lshl_b32 s26, s26, 8
  s_add_u32 s42, s42, s89
  s_add_u32 s26, s26, s21
  v_fmac_f32_dpp v0, v1, v44 row_ror:8 row_mask:0xf bank_mask:0xf
  v_fmac_f32 v53, v45, v0
  s_and_b32 s27, s27, 3
  ds_read_b64_tr_b16 a[16:17], v29 offset:4096
  ds_read_b64_tr_b16 a[18:19], v29 offset:5120
  ds_read_b64_tr_b16 a[20:21], v30 offset:4096
  ds_read_b64_tr_b16 a[22:23], v30 offset:5120
  s_add_u32 m0, s89, 106496
  s_lshl4_add_u32 s95, s17, 458752
  v_mfma_f32_32x32x16_bf16 v[184:199], v[132:135], a[24:27], v[184:199]
  buffer_load_dwordx4 v28, s[44:47], s95 offen lds
  s_lshl_b32 s43, s27, 13
  s_lshl_b32 s27, s27, 8
  v_fmac_f32_dpp v53, v0, v46 row_ror:8 row_mask:0xf bank_mask:0xf
  v_mul_f32_e64 v22, v41, v53
  s_add_u32 s43, s43, s89
  s_add_u32 s27, s27, s21
  v_fmac_f32_dpp v22, v53, v42 row_ror:8 row_mask:0xf bank_mask:0xf
  s_add_u32 m0, s89, 114688
  s_lshl4_add_u32 s95, s17, 917504
  v_mfma_f32_32x32x16_bf16 v[200:215], v[132:135], a[28:31], v[200:215]
  buffer_load_dwordx4 v28, s[44:47], s95 offen lds
  v_mul_f32 v23, v39, v22
  s_nop 1
  v_fmac_f32_dpp v23, v22, -v40 row_ror:8 row_mask:0xf bank_mask:0xf
  v_mul_f32_e64 v22, v39, v23
  v_add_f32 v72, v72, v23
  s_nop 0
  v_fmac_f32_dpp v22, v23, -v40 row_ror:8 row_mask:0xf bank_mask:0xf
  v_mul_f32 v23, v39, v22
  v_add_f32 v73, v73, v22
  ds_read_b64_tr_b16 a[24:25], v29 offset:6144
  ds_read_b64_tr_b16 a[26:27], v29 offset:7168
  ds_read_b64_tr_b16 a[28:29], v30 offset:6144
  ds_read_b64_tr_b16 a[30:31], v30 offset:7168
  s_add_u32 m0, s89, 122880
  s_lshl4_add_u32 s95, s17, 1376256
  v_mfma_f32_32x32x16_bf16 v[184:199], v[136:139], a[0:3], v[184:199]
  buffer_load_dwordx4 v28, s[44:47], s95 offen lds
  v_fmac_f32_dpp v23, v22, -v40 row_ror:8 row_mask:0xf bank_mask:0xf
  v_mul_f32 v22, v39, v23
  v_add_f32 v74, v74, v23
  v_cvt_pk_bf16_f32 v0, v72, v73
  v_fmac_f32_dpp v22, v23, -v40 row_ror:8 row_mask:0xf bank_mask:0xf
  v_mul_f32 v23, v39, v22
  v_add_f32 v75, v75, v22
  v_mfma_f32_32x32x16_bf16 v[200:215], v[136:139], a[4:7], v[200:215]
  v_fmac_f32_dpp v23, v22, -v40 row_ror:8 row_mask:0xf bank_mask:0xf
  v_mul_f32 v22, v39, v23
  v_add_f32 v76, v76, v23
  v_cvt_pk_bf16_f32 v1, v74, v75
  v_fmac_f32_dpp v22, v23, -v40 row_ror:8 row_mask:0xf bank_mask:0xf
  v_mul_f32_e64 v23, v39, v22
  v_add_f32 v77, v77, v22
  s_add_u32 m0, s89, 65536
  s_lshl4_add_u32 s95, s18, 0
  v_mfma_f32_32x32x16_bf16 v[184:199], v[140:143], a[8:11], v[184:199]
  buffer_load_dwordx4 v28, s[44:47], s95 offen lds
  v_fmac_f32_dpp v23, v22, -v40 row_ror:8 row_mask:0xf bank_mask:0xf
  v_mul_f32 v22, v39, v23
  v_add_f32 v78, v78, v23
  v_cvt_pk_bf16_f32 v2, v76, v77
  v_fmac_f32_dpp v22, v23, -v40 row_ror:8 row_mask:0xf bank_mask:0xf
  v_mul_f32 v23, v39, v22
  v_add_f32 v79, v79, v22
  s_add_u32 m0, s89, 73728
  s_lshl4_add_u32 s95, s18, 458752
  v_mfma_f32_32x32x16_bf16 v[200:215], v[140:143], a[12:15], v[200:215]
  buffer_load_dwordx4 v28, s[44:47], s95 offen lds
  v_fmac_f32_dpp v23, v22, -v40 row_ror:8 row_mask:0xf bank_mask:0xf
  v_mul_f32 v22, v39, v23
  v_add_f32 v80, v80, v23
  v_cvt_pk_bf16_f32 v3, v78, v79
  v_fmac_f32_dpp v22, v23, -v40 row_ror:8 row_mask:0xf bank_mask:0xf
  ds_write_b128 v20, v[0:3] offset:8192
  v_mul_f32 v23, v39, v22
  s_waitcnt lgkmcnt(5)
  s_add_u32 m0, s89, 81920
  s_lshl4_add_u32 s95, s18, 917504
  v_mfma_f32_32x32x16_bf16 v[184:199], v[144:147], a[16:19], v[184:199]
  buffer_load_dwordx4 v28, s[44:47], s95 offen lds
  v_add_f32_e64 v81, v81, v22
  v_fmac_f32_dpp v23, v22, -v40 row_ror:8 row_mask:0xf bank_mask:0xf
  v_mul_f32 v22, v39, v23
  v_add_f32 v82, v82, v23
  v_cvt_pk_bf16_f32 v4, v80, v81
  v_fmac_f32_dpp v22, v23, -v40 row_ror:8 row_mask:0xf bank_mask:0xf
  v_mul_f32_e64 v23, v39, v22
  s_add_u32 m0, s89, 90112
  s_lshl4_add_u32 s95, s18, 1376256
  v_mfma_f32_32x32x16_bf16 v[200:215], v[144:147], a[20:23], v[200:215]
  buffer_load_dwordx4 v28, s[44:47], s95 offen lds
  v_add_f32_e64 v83, v83, v22
  v_fmac_f32_dpp v23, v22, -v40 row_ror:8 row_mask:0xf bank_mask:0xf
  v_mul_f32 v22, v39, v23
  v_add_f32 v84, v84, v23
  v_cvt_pk_bf16_f32 v5, v82, v83
  v_fmac_f32_dpp v22, v23, -v40 row_ror:8 row_mask:0xf bank_mask:0xf
  v_mul_f32 v23, v39, v22
  s_waitcnt lgkmcnt(1)
  v_mfma_f32_32x32x16_bf16 v[184:199], v[148:151], a[24:27], v[184:199]
  buffer_load_dword v32, v24, s[56:59], 0 offen offset:512 sc1
  v_add_f32_e64 v85, v85, v22
  v_fmac_f32_dpp v23, v22, -v40 row_ror:8 row_mask:0xf bank_mask:0xf
  v_mul_f32 v22, v39, v23
  v_add_f32 v86, v86, v23
  v_cvt_pk_bf16_f32 v6, v84, v85
  v_fmac_f32_dpp v22, v23, -v40 row_ror:8 row_mask:0xf bank_mask:0xf
  v_add_f32_e64 v87, v87, v22
  v_mfma_f32_32x32x16_bf16 v[200:215], v[148:151], a[28:31], v[200:215]
  v_cvt_pk_bf16_f32 v7, v86, v87
  ds_write_b128 v20, v[4:7] offset:8208
  ds_read_b64_tr_b16 v[72:73], v21 offset:8192
  ds_read_b64_tr_b16 v[74:75], v21 offset:8448
  ds_read_b64_tr_b16 v[76:77], v21 offset:9216
  ds_read_b64_tr_b16 v[78:79], v21 offset:9472
  s_add_u32 s90, s91, 8192
  s_waitcnt vmcnt(8) lgkmcnt(0)
  s_barrier
  buffer_store_dwordx4 v[72:75], v55, s[56:59], s91 offen sc1
  buffer_store_dwordx4 v[76:79], v55, s[56:59], s90 offen sc1
  s_mov_b32 s93, 0x4000
  s_waitcnt vmcnt(2)
Lpl_15:
  v_cmp_eq_u32 s[100:101], v25, v32
  s_nop 0
  s_cmp_eq_u64 s[100:101], -1
  s_cbranch_scc1 Lpd_16
  s_sub_u32 s93, s93, 1
  s_cbranch_scc1 Lpd_16
  buffer_load_dword v32, v24, s[56:59], 0 offen offset:512 sc1
  s_waitcnt vmcnt(0)
  s_branch Lpl_15
Lpd_16:
  s_add_u32 s94, s16, 28672
  buffer_load_dwordx4 v[152:155], v26, s[56:59], s94 offen offset:0 sc1
  v_and_b32_e64 v0, 31, v52
  v_bfe_u32 v1, v52, 1, 3
  v_lshrrev_b32 v2, 5, v52
  v_xor_b32 v1, v1, v2
  v_lshl_add_u32 v1, v0, 3, v1
  s_lshl_b32 s30, s81, 13
  v_lshl_add_u32 v33, v1, 4, s30
  v_xor_b32 v34, 32, v33
  v_xor_b32_e64 v35, 64, v33
  v_xor_b32 v36, 96, v33
  v_bfe_u32 v0, v52, 3, 1
  buffer_load_dwordx4 v[156:159], v26, s[56:59], s94 offen offset:2048 sc1
  v_lshrrev_b32 v1, 4, v52
  v_and_b32 v2, 15, v52
  v_lshl_add_u32 v3, v0, 2, v1
  v_lshlrev_b32_e64 v10, 3, v2
  v_lshl_add_u32 v8, v3, 7, v10
  v_add_u32_e64 v8, s89, v8
  v_lshl_add_u32 v3, s80, 3, v3
  v_lshlrev_b32_e64 v9, 3, v3
  v_lshl_add_u32 v3, s87, 6, v3
  v_lshl_add_u32 v4, s88, 4, v2
  s_add_u32 s94, s16, 32768
  buffer_load_dwordx4 v[160:163], v26, s[56:59], s94 offen offset:0 sc1
  v_lshl_add_u32 v4, v3, 7, v4
  v_lshlrev_b32_e64 v37, 4, v4
  v_mul_u32_u24 v0, 4224, v0
  v_lshl_add_u32 v0, v1, 8, v0
  v_and_b32_e64 v2, 7, v2
  v_lshl_add_u32 v0, v2, 4, v0
  s_lshl_b32 s30, s82, 5
  s_add_u32 s30, s30, s81
  v_lshl_add_u32 v38, s30, 10, v0
  v_xor_b32 v11, 512, v8
  buffer_load_dwordx4 v[164:167], v26, s[56:59], s94 offen offset:2048 sc1
  v_xor_b32_e64 v12, 32, v9
  ds_read_b64 v[64:65], v10 offset:3584
  ds_read_b64 v[84:85], v8 offset:24576
  ds_read_b64 v[80:81], v9 offset:3072
  ds_read_b64 v[86:87], v11 offset:24576
  ds_read_b64 v[82:83], v12 offset:3072
  s_add_u32 m0, s40, 32768
  s_nop 0
  buffer_load_dwordx4 v27, s[48:51], s24 offen lds
  s_waitcnt lgkmcnt(4)
  v_lshlrev_b32_e64 v0, 16, v64
  v_and_b32 v1, 0xffff0000, v64
  v_lshlrev_b32_e64 v2, 16, v65
  v_and_b32 v3, 0xffff0000, v65
  s_waitcnt lgkmcnt(3)
  v_lshlrev_b32 v56, 16, v84
  v_and_b32 v57, 0xffff0000, v84
  s_add_u32 m0, s41, 32768
  s_nop 0
  buffer_load_dwordx4 v27, s[48:51], s25 offen lds
  v_lshlrev_b32 v58, 16, v85
  v_and_b32 v59, 0xffff0000, v85
  s_waitcnt lgkmcnt(2)
  v_sub_f32 v4, v56, v80
  v_mul_f32 v5, v81, v0
  v_fmac_f32 v56, v4, v5
  v_sub_f32 v4, v57, v80
  v_mul_f32 v5, v81, v1
  v_fmac_f32 v57, v4, v5
  v_sub_f32 v4, v58, v80
  v_mul_f32 v5, v81, v2
  s_add_u32 m0, s42, 32768
  s_nop 0
  buffer_load_dwordx4 v27, s[48:51], s26 offen lds
  v_fmac_f32 v58, v4, v5
  v_sub_f32 v4, v59, v80
  v_mul_f32 v5, v81, v3
  v_fmac_f32 v59, v4, v5
  s_waitcnt lgkmcnt(1)
  v_lshlrev_b32 v60, 16, v86
  v_and_b32 v61, 0xffff0000, v86
  v_lshlrev_b32_e64 v62, 16, v87
  v_and_b32 v63, 0xffff0000, v87
  s_waitcnt lgkmcnt(0)
  v_sub_f32 v4, v60, v82
  v_mul_f32 v5, v83, v0
  s_add_u32 m0, s43, 32768
  s_nop 0
  buffer_load_dwordx4 v27, s[48:51], s27 offen lds
  v_fmac_f32 v60, v4, v5
  v_sub_f32 v4, v61, v82
  v_mul_f32 v5, v83, v1
  v_fmac_f32 v61, v4, v5
  v_sub_f32 v4, v62, v82
  v_mul_f32 v5, v83, v2
  v_fmac_f32 v62, v4, v5
  v_sub_f32 v4, v63, v82
  v_mul_f32 v5, v83, v3
  v_fmac_f32 v63, v4, v5
  s_waitcnt vmcnt(8)
  s_barrier
  s_cmp_lg_u32 s80, 0
  s_cbranch_scc1 Lfl_17
  v_mov_b32_e64 v22, s96
  v_mov_b32 v23, s97
  s_mov_b64 exec, 1
  buffer_store_dwordx2 v[22:23], off, s[56:59], s92 offset:1024 sc1
  s_mov_b64 exec, -1
Lfl_17:
  s_add_u32 s94, s17, 28672
  buffer_load_dwordx4 v[168:171], v26, s[56:59], s94 offen offset:0 sc1
  buffer_load_dwordx4 v[172:175], v26, s[56:59], s94 offen offset:2048 sc1
  s_add_u32 s94, s17, 32768
  buffer_load_dwordx4 v[176:179], v26, s[56:59], s94 offen offset:0 sc1
  buffer_load_dwordx4 v[180:183], v26, s[56:59], s94 offen offset:2048 sc1
  v_add_u32 v29, 0x10000, v29
  v_add_u32 v30, 0x10000, v30
  ds_read_b64_tr_b16 a[0:1], v29 offset:32768
  ds_read_b64_tr_b16 a[2:3], v29 offset:33792
  ds_read_b64_tr_b16 a[4:5], v30 offset:32768
  ds_read_b64_tr_b16 a[6:7], v30 offset:33792
  ds_read_b64_tr_b16 a[8:9], v29 offset:34816
  ds_read_b64_tr_b16 a[10:11], v29 offset:35840
  ds_read_b64_tr_b16 a[12:13], v30 offset:34816
  ds_read_b64_tr_b16 a[14:15], v30 offset:35840
  ds_read_b64_tr_b16 a[16:17], v29 offset:36864
  ds_read_b64_tr_b16 a[18:19], v29 offset:37888
  ds_read_b64_tr_b16 a[20:21], v30 offset:36864
  ds_read_b64_tr_b16 a[22:23], v30 offset:37888
  ds_read_b64_tr_b16 a[24:25], v29 offset:38912
  ds_read_b64_tr_b16 a[26:27], v29 offset:39936
  ds_read_b64_tr_b16 a[28:29], v30 offset:38912
  ds_read_b64_tr_b16 a[30:31], v30 offset:39936
  s_waitcnt vmcnt(11) lgkmcnt(12)
  v_mfma_f32_32x32x16_bf16 v[184:199], v[152:155], a[0:3], v[184:199]
  s_add_u32 s94, s18, 28672
  buffer_load_dwordx4 v[88:91], v26, s[56:59], s94 offen offset:0 sc1
  v_mfma_f32_32x32x16_bf16 v[200:215], v[152:155], a[4:7], v[200:215]
  ds_read_b64_tr_b16 a[0:1], v29 offset:0
  ds_read_b64_tr_b16 a[2:3], v29 offset:1024
  ds_read_b64_tr_b16 a[4:5], v30 offset:0
  ds_read_b64_tr_b16 a[6:7], v30 offset:1024
  s_waitcnt vmcnt(11) lgkmcnt(12)
  v_mfma_f32_32x32x16_bf16 v[184:199], v[156:159], a[8:11], v[184:199]
  buffer_load_dwordx4 v[92:95], v26, s[56:59], s94 offen offset:2048 sc1
  v_mfma_f32_32x32x16_bf16 v[200:215], v[156:159], a[12:15], v[200:215]
  s_add_u32 s94, s18, 32768
  buffer_load_dwordx4 v[96:99], v26, s[56:59], s94 offen offset:0 sc1
  ds_read_b64_tr_b16 a[8:9], v29 offset:2048
  ds_read_b64_tr_b16 a[10:11], v29 offset:3072
  ds_read_b64_tr_b16 a[12:13], v30 offset:2048
  ds_read_b64_tr_b16 a[14:15], v30 offset:3072
  s_waitcnt vmcnt(12) lgkmcnt(12)
  v_mfma_f32_32x32x16_bf16 v[184:199], v[160:163], a[16:19], v[184:199]
  v_mfma_f32_32x32x16_bf16 v[200:215], v[160:163], a[20:23], v[200:215]
  buffer_load_dwordx4 v[100:103], v26, s[56:59], s94 offen offset:2048 sc1
  ds_read_b64_tr_b16 a[16:17], v29 offset:4096
  ds_read_b64_tr_b16 a[18:19], v29 offset:5120
  ds_read_b64_tr_b16 a[20:21], v30 offset:4096
  ds_read_b64_tr_b16 a[22:23], v30 offset:5120
  s_waitcnt vmcnt(12) lgkmcnt(12)
  s_add_u32 m0, s40, 0
  v_mfma_f32_32x32x16_bf16 v[184:199], v[164:167], a[24:27], v[184:199]
  buffer_load_dwordx4 v27, s[52:55], s24 offen lds
  v_mfma_f32_32x32x16_bf16 v[200:215], v[164:167], a[28:31], v[200:215]
  ds_read_b64_tr_b16 a[24:25], v29 offset:6144
  ds_read_b64_tr_b16 a[26:27], v29 offset:7168
  ds_read_b64_tr_b16 a[28:29], v30 offset:6144
  ds_read_b64_tr_b16 a[30:31], v30 offset:7168
  s_waitcnt vmcnt(8) lgkmcnt(12)
  s_add_u32 m0, s41, 0
  v_mfma_f32_32x32x16_bf16 v[184:199], v[168:171], a[0:3], v[184:199]
  buffer_load_dwordx4 v27, s[52:55], s25 offen lds
  v_mfma_f32_32x32x16_bf16 v[200:215], v[168:171], a[4:7], v[200:215]
  s_waitcnt vmcnt(8) lgkmcnt(8)
  s_add_u32 m0, s42, 0
  v_mfma_f32_32x32x16_bf16 v[184:199], v[172:175], a[8:11], v[184:199]
  buffer_load_dwordx4 v27, s[52:55], s26 offen lds
  v_mfma_f32_32x32x16_bf16 v[200:215], v[172:175], a[12:15], v[200:215]
  s_waitcnt vmcnt(8) lgkmcnt(4)
  s_add_u32 m0, s43, 0
  v_mfma_f32_32x32x16_bf16 v[184:199], v[176:179], a[16:19], v[184:199]
  buffer_load_dwordx4 v27, s[52:55], s27 offen lds
  v_mfma_f32_32x32x16_bf16 v[200:215], v[176:179], a[20:23], v[200:215]
  s_waitcnt vmcnt(8) lgkmcnt(0)
  v_mfma_f32_32x32x16_bf16 v[184:199], v[180:183], a[24:27], v[184:199]
  v_mfma_f32_32x32x16_bf16 v[200:215], v[180:183], a[28:31], v[200:215]
  s_barrier
  s_add_u32 m0, s40, 131072
  s_xor_b32 s95, s24, 128
  buffer_load_dwordx4 v27, s[48:51], s95 offen lds
  s_add_u32 m0, s41, 131072
  s_xor_b32 s95, s25, 128
  buffer_load_dwordx4 v27, s[48:51], s95 offen lds
  buffer_load_dword v32, v24, s[56:59], 0 offen offset:1024 sc1
  s_add_u32 m0, s42, 131072
  s_xor_b32 s95, s26, 128
  buffer_load_dwordx4 v27, s[48:51], s95 offen lds
  v_add_u32 v29, 0xffff0000, v29
  v_add_u32 v30, 0xffff0000, v30
  ds_read_b64_tr_b16 a[0:1], v29 offset:32768
  ds_read_b64_tr_b16 a[2:3], v29 offset:33792
  ds_read_b64_tr_b16 a[4:5], v30 offset:32768
  ds_read_b64_tr_b16 a[6:7], v30 offset:33792
  ds_read_b64_tr_b16 a[8:9], v29 offset:34816
  ds_read_b64_tr_b16 a[10:11], v29 offset:35840
  ds_read_b64_tr_b16 a[12:13], v30 offset:34816
  ds_read_b64_tr_b16 a[14:15], v30 offset:35840
  ds_read_b64_tr_b16 a[16:17], v29 offset:36864
  ds_read_b64_tr_b16 a[18:19], v29 offset:37888
  ds_read_b64_tr_b16 a[20:21], v30 offset:36864
  ds_read_b64_tr_b16 a[22:23], v30 offset:37888
  ds_read_b64_tr_b16 a[24:25], v29 offset:38912
  ds_read_b64_tr_b16 a[26:27], v29 offset:39936
  ds_read_b64_tr_b16 a[28:29], v30 offset:38912
  ds_read_b64_tr_b16 a[30:31], v30 offset:39936
  s_waitcnt vmcnt(11) lgkmcnt(12)
  s_add_u32 m0, s43, 131072
  s_xor_b32 s95, s27, 128
  v_mfma_f32_32x32x16_bf16 v[184:199], v[88:91], a[0:3], v[184:199]
  buffer_load_dwordx4 v27, s[48:51], s95 offen lds
  s_add_u32 m0, s40, 98304
  s_xor_b32 s95, s24, 128
  buffer_load_dwordx4 v27, s[52:55], s95 offen lds
  s_add_u32 m0, s41, 98304
  s_xor_b32 s95, s25, 128
  v_mfma_f32_32x32x16_bf16 v[200:215], v[88:91], a[4:7], v[200:215]
  buffer_load_dwordx4 v27, s[52:55], s95 offen lds
  s_waitcnt vmcnt(13) lgkmcnt(8)
  s_add_u32 m0, s42, 98304
  s_xor_b32 s95, s26, 128
  v_mfma_f32_32x32x16_bf16 v[184:199], v[92:95], a[8:11], v[184:199]
  buffer_load_dwordx4 v27, s[52:55], s95 offen lds
  s_add_u32 m0, s43, 98304
  s_xor_b32 s95, s27, 128
  buffer_load_dwordx4 v27, s[52:55], s95 offen lds
  v_mfma_f32_32x32x16_bf16 v[200:215], v[92:95], a[12:15], v[200:215]
  s_mov_b32 s93, 0x4000
  s_waitcnt vmcnt(6)
Lpl_18:
  v_cmp_eq_u32 s[100:101], v25, v32
  s_nop 0
  s_cmp_eq_u64 s[100:101], -1
  s_cbranch_scc1 Lpd_19
  s_sub_u32 s93, s93, 1
  s_cbranch_scc1 Lpd_19
  buffer_load_dword v32, v24, s[56:59], 0 offen offset:1024 sc1
  s_waitcnt vmcnt(0)
  s_branch Lpl_18
Lpd_19:
  s_waitcnt lgkmcnt(4)
  v_mfma_f32_32x32x16_bf16 v[184:199], v[96:99], a[16:19], v[184:199]
  v_mfma_f32_32x32x16_bf16 v[200:215], v[96:99], a[20:23], v[200:215]
  s_waitcnt lgkmcnt(0)
  v_mfma_f32_32x32x16_bf16 v[184:199], v[100:103], a[24:27], v[184:199]
  s_add_u32 s94, s19, 57344
  buffer_load_dwordx4 v[104:107], v26, s[56:59], s94 offen offset:0 sc1
  v_mfma_f32_32x32x16_bf16 v[200:215], v[100:103], a[28:31], v[200:215]
  buffer_load_dwordx4 v[108:111], v26, s[56:59], s94 offen offset:2048 sc1
  s_add_u32 s94, s19, 61440
  buffer_load_dwordx4 v[112:115], v26, s[56:59], s94 offen offset:0 sc1
  buffer_load_dwordx4 v[116:119], v26, s[56:59], s94 offen offset:2048 sc1
  s_waitcnt vmcnt(8)
  s_barrier
  s_lshl3_add_u32 s30, s87, s88
  s_lshl3_add_u32 s30, s30, s80
  s_cmp_lg_u32 s30, 2040
  s_cbranch_scc1 Lnn_20
  v_mov_b32 v22, s96
  v_mov_b32 v23, s97
  s_mov_b64 exec, 1
  buffer_store_dwordx2 v[22:23], off, s[56:59], 0 sc1
  s_mov_b64 exec, -1
Lnn_20:
  s_add_u32 s94, s19, 65536
  buffer_load_dwordx4 v[120:123], v26, s[56:59], s94 offen offset:0 sc1
  buffer_load_dwordx4 v[124:127], v26, s[56:59], s94 offen offset:2048 sc1
  s_add_u32 s94, s19, 69632
  buffer_load_dwordx4 v[128:131], v26, s[56:59], s94 offen offset:0 sc1
  buffer_load_dwordx4 v[132:135], v26, s[56:59], s94 offen offset:2048 sc1
  s_add_u32 s94, s20, 57344
  buffer_load_dwordx4 v[136:139], v26, s[56:59], s94 offen offset:0 sc1
  buffer_load_dwordx4 v[140:143], v26, s[56:59], s94 offen offset:2048 sc1
  ds_read_b128 a[0:3], v33 offset:32768
  ds_read_b128 a[4:7], v33 offset:36864
  ds_read_b128 a[8:11], v34 offset:32768
  ds_read_b128 a[12:15], v34 offset:36864
  ds_read_b128 a[16:19], v35 offset:32768
  ds_read_b128 a[20:23], v35 offset:36864
  ds_read_b128 a[24:27], v36 offset:32768
  ds_read_b128 a[28:31], v36 offset:36864
  s_waitcnt vmcnt(9) lgkmcnt(6)
  v_mfma_f32_32x32x16_bf16 v[184:199], v[104:107], a[0:3], v[184:199]
  s_add_u32 s94, s20, 61440
  buffer_load_dwordx4 v[144:147], v26, s[56:59], s94 offen offset:0 sc1
  v_mfma_f32_32x32x16_bf16 v[200:215], v[104:107], a[4:7], v[200:215]
  ds_read_b128 a[0:3], v33 offset:0
  ds_read_b128 a[4:7], v33 offset:4096
  s_waitcnt vmcnt(9) lgkmcnt(6)
  v_mfma_f32_32x32x16_bf16 v[184:199], v[108:111], a[8:11], v[184:199]
  v_mfma_f32_32x32x16_bf16 v[200:215], v[108:111], a[12:15], v[200:215]
  ds_read_b128 a[8:11], v34 offset:0
  ds_read_b128 a[12:15], v34 offset:4096
  s_waitcnt vmcnt(8) lgkmcnt(6)
  v_mfma_f32_32x32x16_bf16 v[184:199], v[112:115], a[16:19], v[184:199]
  buffer_load_dwordx4 v[148:151], v26, s[56:59], s94 offen offset:2048 sc1
  v_mfma_f32_32x32x16_bf16 v[200:215], v[112:115], a[20:23], v[200:215]
  ds_read_b128 a[16:19], v35 offset:0
  ds_read_b128 a[20:23], v35 offset:4096
  s_waitcnt vmcnt(8) lgkmcnt(6)
  v_mfma_f32_32x32x16_bf16 v[184:199], v[116:119], a[24:27], v[184:199]
  s_add_u32 s94, s20, 65536
  buffer_load_dwordx4 v[152:155], v26, s[56:59], s94 offen offset:0 sc1
  v_mfma_f32_32x32x16_bf16 v[200:215], v[116:119], a[28:31], v[200:215]
  ds_read_b128 a[24:27], v36 offset:0
  ds_read_b128 a[28:31], v36 offset:4096
  s_waitcnt vmcnt(8) lgkmcnt(6)
  v_mfma_f32_32x32x16_bf16 v[184:199], v[120:123], a[0:3], v[184:199]
  v_mfma_f32_32x32x16_bf16 v[200:215], v[120:123], a[4:7], v[200:215]
  v_add_u32 v33, 0x18000, v33
  v_add_u32 v34, 0x18000, v34
  v_add_u32 v35, 0x18000, v35
  v_add_u32 v36, 0x18000, v36
  ds_read_b128 a[0:3], v33 offset:32768
  ds_read_b128 a[4:7], v33 offset:36864
  s_waitcnt vmcnt(7) lgkmcnt(6)
  v_mfma_f32_32x32x16_bf16 v[184:199], v[124:127], a[8:11], v[184:199]
  v_mfma_f32_32x32x16_bf16 v[200:215], v[124:127], a[12:15], v[200:215]
  buffer_load_dwordx4 v[156:159], v26, s[56:59], s94 offen offset:2048 sc1
  ds_read_b128 a[8:11], v34 offset:32768
  ds_read_b128 a[12:15], v34 offset:36864
  s_waitcnt vmcnt(7) lgkmcnt(6)
  v_mfma_f32_32x32x16_bf16 v[184:199], v[128:131], a[16:19], v[184:199]
  v_mfma_f32_32x32x16_bf16 v[200:215], v[128:131], a[20:23], v[200:215]
  s_add_u32 s94, s20, 69632
  buffer_load_dwordx4 v[160:163], v26, s[56:59], s94 offen offset:0 sc1
  ds_read_b128 a[16:19], v35 offset:32768
  ds_read_b128 a[20:23], v35 offset:36864
  s_waitcnt vmcnt(7) lgkmcnt(6)
  v_mfma_f32_32x32x16_bf16 v[184:199], v[132:135], a[24:27], v[184:199]
  v_mfma_f32_32x32x16_bf16 v[200:215], v[132:135], a[28:31], v[200:215]
  ds_read_b128 a[24:27], v36 offset:32768
  ds_read_b128 a[28:31], v36 offset:36864
  s_waitcnt vmcnt(6) lgkmcnt(6)
  v_mfma_f32_32x32x16_bf16 v[184:199], v[136:139], a[0:3], v[184:199]
  v_mfma_f32_32x32x16_bf16 v[200:215], v[136:139], a[4:7], v[200:215]
  buffer_load_dwordx4 v[164:167], v26, s[56:59], s94 offen offset:2048 sc1
  s_waitcnt vmcnt(6) lgkmcnt(4)
  v_mfma_f32_32x32x16_bf16 v[184:199], v[140:143], a[8:11], v[184:199]
  v_mfma_f32_32x32x16_bf16 v[200:215], v[140:143], a[12:15], v[200:215]
  s_waitcnt vmcnt(5) lgkmcnt(2)
  v_mfma_f32_32x32x16_bf16 v[184:199], v[144:147], a[16:19], v[184:199]
  v_mfma_f32_32x32x16_bf16 v[200:215], v[144:147], a[20:23], v[200:215]
  s_waitcnt vmcnt(4) lgkmcnt(0)
  v_mfma_f32_32x32x16_bf16 v[184:199], v[148:151], a[24:27], v[184:199]
  v_mfma_f32_32x32x16_bf16 v[200:215], v[148:151], a[28:31], v[200:215]
  s_barrier
  ds_read_b128 a[0:3], v33 offset:0
  ds_read_b128 a[4:7], v33 offset:4096
  ds_read_b128 a[8:11], v34 offset:0
  ds_read_b128 a[12:15], v34 offset:4096
  ds_read_b128 a[16:19], v35 offset:0
  ds_read_b128 a[20:23], v35 offset:4096
  ds_read_b128 a[24:27], v36 offset:0
  ds_read_b128 a[28:31], v36 offset:4096
  s_waitcnt vmcnt(3) lgkmcnt(6)
  v_mfma_f32_32x32x16_bf16 v[184:199], v[152:155], a[0:3], v[184:199]
  v_mfma_f32_32x32x16_bf16 v[200:215], v[152:155], a[4:7], v[200:215]
  s_waitcnt vmcnt(2) lgkmcnt(4)
  v_mfma_f32_32x32x16_bf16 v[184:199], v[156:159], a[8:11], v[184:199]
  v_mfma_f32_32x32x16_bf16 v[200:215], v[156:159], a[12:15], v[200:215]
  s_waitcnt vmcnt(1) lgkmcnt(2)
  v_mfma_f32_32x32x16_bf16 v[184:199], v[160:163], a[16:19], v[184:199]
  v_mfma_f32_32x32x16_bf16 v[200:215], v[160:163], a[20:23], v[200:215]
  s_waitcnt vmcnt(0) lgkmcnt(0)
  v_mfma_f32_32x32x16_bf16 v[184:199], v[164:167], a[24:27], v[184:199]
  v_mfma_f32_32x32x16_bf16 v[200:215], v[164:167], a[28:31], v[200:215]
  s_lshl_b32 m0, s89, 3
  v_xor_b32 v0, 128, v38
  v_xor_b32 v1, 0x2000, v37
  s_nop 7
  ds_write_addtid_b32 v184 offset:0
  ds_write_addtid_b32 v185 offset:256
  ds_write_addtid_b32 v186 offset:512
  ds_write_addtid_b32 v187 offset:768
  ds_write_addtid_b32 v188 offset:1024
  ds_write_addtid_b32 v189 offset:1280
  ds_write_addtid_b32 v190 offset:1536
  ds_write_addtid_b32 v191 offset:1792
  ds_write_addtid_b32 v192 offset:2048
  ds_write_addtid_b32 v193 offset:2304
  ds_write_addtid_b32 v194 offset:2560
  ds_write_addtid_b32 v195 offset:2816
  ds_write_addtid_b32 v196 offset:3072
  ds_write_addtid_b32 v197 offset:3328
  ds_write_addtid_b32 v198 offset:3584
  ds_write_addtid_b32 v199 offset:3840
  ds_write_addtid_b32 v200 offset:4096
  ds_write_addtid_b32 v201 offset:4352
  ds_write_addtid_b32 v202 offset:4608
  ds_write_addtid_b32 v203 offset:4864
  ds_write_addtid_b32 v204 offset:5120
  ds_write_addtid_b32 v205 offset:5376
  ds_write_addtid_b32 v206 offset:5632
  ds_write_addtid_b32 v207 offset:5888
  ds_write_addtid_b32 v208 offset:6144
  ds_write_addtid_b32 v209 offset:6400
  ds_write_addtid_b32 v210 offset:6656
  ds_write_addtid_b32 v211 offset:6912
  ds_write_addtid_b32 v212 offset:7168
  ds_write_addtid_b32 v213 offset:7424
  ds_write_addtid_b32 v214 offset:7680
  ds_write_addtid_b32 v215 offset:7936
  s_waitcnt lgkmcnt(0)
  s_barrier
  ds_read_b128 v[88:91], v38 offset:0
  ds_read_b128 v[92:95], v38 offset:8192
  ds_read_b128 v[96:99], v38 offset:16384
  ds_read_b128 v[100:103], v38 offset:24576
  ds_read_b128 v[104:107], v0 offset:0
  ds_read_b128 v[108:111], v0 offset:8192
  ds_read_b128 v[112:115], v0 offset:16384
  ds_read_b128 v[116:119], v0 offset:24576
  s_waitcnt lgkmcnt(7)
  v_add_f32 v56, v56, v88
  v_add_f32 v57, v57, v89
  v_add_f32 v58, v58, v90
  v_add_f32 v59, v59, v91
  s_waitcnt lgkmcnt(6)
  v_add_f32 v56, v56, v92
  v_add_f32 v57, v57, v93
  v_add_f32 v58, v58, v94
  v_add_f32 v59, v59, v95
  s_waitcnt lgkmcnt(5)
  v_add_f32 v56, v56, v96
  v_add_f32 v57, v57, v97
  v_add_f32 v58, v58, v98
  v_add_f32 v59, v59, v99
  s_waitcnt lgkmcnt(4)
  v_add_f32 v56, v56, v100
  v_add_f32 v57, v57, v101
  v_add_f32 v58, v58, v102
  v_add_f32 v59, v59, v103
  buffer_store_dwordx4 v[56:59], v37, s[60:63], 0 offen nt
  s_waitcnt lgkmcnt(3)
  v_add_f32 v60, v60, v104
  v_add_f32 v61, v61, v105
  v_add_f32 v62, v62, v106
  v_add_f32 v63, v63, v107
  s_waitcnt lgkmcnt(2)
  v_add_f32 v60, v60, v108
  v_add_f32 v61, v61, v109
  v_add_f32 v62, v62, v110
  v_add_f32 v63, v63, v111
  s_waitcnt lgkmcnt(1)
  v_add_f32 v60, v60, v112
  v_add_f32 v61, v61, v113
  v_add_f32 v62, v62, v114
  v_add_f32 v63, v63, v115
  s_waitcnt lgkmcnt(0)
  v_add_f32 v60, v60, v116
  v_add_f32 v61, v61, v117
  v_add_f32 v62, v62, v118
  v_add_f32 v63, v63, v119
  buffer_store_dwordx4 v[60:63], v1, s[60:63], 0 offen nt
L_exit:
  s_endpgm
L_end:
.section .rodata,"a"
.p2align 6
.amdhsa_kernel parallel_sum__ssm_conv_s5__dense_activation_silu__prompt_kernel
  .amdhsa_next_free_vgpr 256
  .amdhsa_next_free_sgpr 102
  .amdhsa_accum_offset 216
  .amdhsa_group_segment_fixed_size 0
  .amdhsa_kernarg_size 120
  .amdhsa_user_sgpr_count 2
  .amdhsa_user_sgpr_kernarg_segment_ptr 1
  .amdhsa_system_sgpr_workgroup_id_x 1
.end_amdhsa_kernel
```
